```python
import torch

def _softmax(x, axis=-1):
    return torch.softmax(x, dim=axis)
def _gelu(x):
    return torch.nn.functional.gelu(x, approximate="tanh")
def _silu(x):
    return torch.nn.functional.silu(x)
def _sigmoid(x):
    return torch.sigmoid(x)
def _layernorm(x, axis=-1, eps=1e-5):
    m = x.mean(dim=axis, keepdim=True)
    v = x.var(dim=axis, keepdim=True, unbiased=False)
    return (x - m) / torch.sqrt(v + eps)
def _scatter_add(tgt, idx, src, axis=0):
    return tgt.clone().index_add_(axis, idx, src)
def _segment_sum(src, seg, n):
    out = torch.zeros((n,) + src.shape[1:], dtype=src.dtype)
    return out.index_add_(0, seg, src)
def _pad(x, pw):
    flat = tuple(v for pair in reversed(pw) for v in pair)
    return torch.nn.functional.pad(x, flat)

kernel_name = 'recurrent_scan__ssm_conv_s4d__mixer_channel_mlp__prompt'

def setup_inputs():

    _w = (lambda a: (lambda t: t.to(torch.bfloat16) if t.is_floating_point() else t)(torch.as_tensor(a)))
    def _A_setup():
        Bsz, L, D, N = 1, 2048, 512, 128
        return {
            "u": _w((lambda *s: torch.randn(*s, dtype=torch.bfloat16) * 0.05)(Bsz, L, D)),
            "log_A_real": _w((lambda *s: torch.randn(*s, dtype=torch.bfloat16) * 3.2)(D, N) * 0.5),
            "A_imag": _w((lambda *s: torch.randn(*s, dtype=torch.bfloat16) * 0.2)(D, N) * 3.14),
            "C_real": _w((lambda *s: torch.randn(*s, dtype=torch.bfloat16) * 0.8)(D, N) / N ** 0.5),
            "C_imag": _w((lambda *s: torch.randn(*s, dtype=torch.bfloat16) * 0.8)(D, N) / N ** 0.5),
            "log_dt": _w((lambda *s: torch.randn(*s, dtype=torch.bfloat16) * 0.2)(D) * 0.5 - 4.0),
            "D_skip": _w((lambda *s: torch.randn(*s, dtype=torch.bfloat16) * 0.2)(D)),
        }
    _A_in = _A_setup()

    def _B_setup():
        B, S, D, F = 1, 2048, 512, 1376
        return {
            "x": _w((lambda *s: torch.randn(*s, dtype=torch.bfloat16) * 0.05)(B, S, D)),
            "w1": _w((lambda *s: torch.randn(*s, dtype=torch.bfloat16) * 1.6)(D, F) * (D ** -0.5)),
            "b1": _w((lambda *s: torch.randn(*s, dtype=torch.bfloat16) * 0.8)(F)),
            "w2": _w((lambda *s: torch.randn(*s, dtype=torch.bfloat16) * 0.1)(F, D) * (F ** -0.5)),
            "b2": _w((lambda *s: torch.randn(*s, dtype=torch.bfloat16) * 0.1)(D)),
        }
    _B_in = _B_setup()

    return {
        "A_u": _A_in["u"],
        "A_log_A_real": _A_in["log_A_real"],
        "A_A_imag": _A_in["A_imag"],
        "A_C_real": _A_in["C_real"],
        "A_C_imag": _A_in["C_imag"],
        "A_log_dt": _A_in["log_dt"],
        "A_D_skip": _A_in["D_skip"],
        "B_x": _B_in["x"],
        "B_w1": _B_in["w1"],
        "B_b1": _B_in["b1"],
        "B_w2": _B_in["w2"],
        "B_b2": _B_in["b2"],
    }

def reference(A_u, A_log_A_real, A_A_imag, A_C_real, A_C_imag, A_log_dt, A_D_skip, B_x, B_w1, B_b1, B_w2, B_b2):
    def _A_ref(u, log_A_real, A_imag, C_real, C_imag, log_dt, D_skip):
        L = u.shape[1]
        dt = torch.exp(log_dt)
        A = -torch.exp(log_A_real) + 1j * A_imag
        C = (C_real + 1j * C_imag) * dt[:, None]
        pos = (lambda x, dt: x.to(dt))(torch.arange(L), log_dt.dtype)
        P = torch.exp((A * dt[:, None])[:, :, None] * pos[None, None, :])
        K = 2.0 * torch.einsum("dn,dnl->dl", C, P).real
        L2 = 2 * L
        u_t = (lambda x, *d: x.permute(*d))(u, 0, 2, 1)
        Kf = (lambda x, *a, **k: torch.fft.rfft(x.float(), *a, **k))(K, L2)
        Uf = (lambda x, *a, **k: torch.fft.rfft(x.float(), *a, **k))(u_t, L2)
        y = (lambda x, *a, **k: torch.fft.irfft(x, *a, **k).to(torch.bfloat16))(Uf * Kf[None, :, :], L2)[:, :, :L]
        y = (lambda x, *d: x.permute(*d))(y, 0, 2, 1)
        return y + u * D_skip[None, None, :]

    def _B_ref(x, w1, b1, w2, b2):
        y = _layernorm(x, axis=-1)
        h = _gelu(torch.einsum("bsd,df->bsf", y, w1) + b1)
        return torch.einsum("bsf,fd->bsd", h, w2) + b2

    x = A_u
    xn = _layernorm(x, axis=-1)
    s = _A_ref(xn, A_log_A_real, A_A_imag, A_C_real, A_C_imag, A_log_dt, A_D_skip)
    g = _silu(_B_ref(xn, B_w1, B_b1, B_w2, B_b2))
    return x + s * g
```

```asm
; @launch grid=(256,1,1) block=(512,1,1) lds=163840
.amdgcn_target "amdgcn-amd-amdhsa--gfx950"
.text
.globl recurrent_scan__ssm_conv_s4d__mixer_channel_mlp__prompt_kernel
.p2align 8
.type recurrent_scan__ssm_conv_s4d__mixer_channel_mlp__prompt_kernel,@function
recurrent_scan__ssm_conv_s4d__mixer_channel_mlp__prompt_kernel:
    s_cmp_ge_u32 s2, 256
    s_cbranch_scc1 L_end
    s_load_dwordx16 s[4:19], s[0:1], 0
    s_load_dwordx8 s[20:27], s[0:1], 64
    s_load_dwordx4 s[28:31], s[0:1], 96
    s_load_dwordx2 s[32:33], s[0:1], 112
    s_getpc_b64 s[38:39]
L_pc:
    s_lshr_b32 s37, s2, 3
    v_lshrrev_b32 v2, 6, v0
    v_lshl_add_u32 v3, v0, 5, s37
    v_lshlrev_b32 v3, 7, v3
    v_readfirstlane_b32 s34, v2
    v_min_u32 v3, L_tabend-L_pc-4, v3
    global_load_dword v255, v3, s[38:39]
    v_and_b32 v1, 63, v0
    s_and_b32 s36, s2, 7
    s_and_b32 s35, s34, 3
    s_lshr_b32 s74, s37, 3
    s_lshr_b32 s75, s36, 1
    s_lshl2_add_u32 s64, s75, s74
    s_and_b32 s69, s37, 7
    s_lshl2_add_u32 s68, s36, s74
    s_and_b32 s75, s36, 1
    s_lshl3_add_u32 s65, s75, s69
    s_lshl4_add_u32 s66, s64, s65
    s_cmp_lt_u32 s34, 4
    s_cbranch_scc1 L_G
    s_lshl_b32 s67, s36, 5
    s_add_u32 s67, s67, s37
    s_lshl2_add_u32 s74, s67, s35
    s_lshl_b32 s74, s74, 7
    v_lshl_add_u32 v20, v1, 1, s74
    v_lshlrev_b32 v21, 4, v1
    s_add_u32 s38, s38, L_tab-L_pc
    s_addc_u32 s39, s39, 0
    s_lshl_b32 s76, s67, 2
    s_waitcnt lgkmcnt(0)
    global_load_ushort v4, v20, s[6:7]
    global_load_ushort v5, v20, s[8:9]
    global_load_ushort v6, v20, s[10:11]
    global_load_ushort v7, v20, s[12:13]
    global_load_dwordx4 v[8:11], v21, s[38:39]
    s_load_dword s86, s[14:15], s76
    s_load_dword s87, s[16:17], s76
    s_branch L_S
L_G:
    v_lshrrev_b32 v2, 5, v1
    v_bfe_u32 v3, v1, 2, 2
    v_lshl_add_u32 v2, v2, 2, v3
    v_and_b32 v3, 3, v1
    v_bfe_u32 v4, v1, 4, 1
    v_lshl_add_u32 v3, v4, 2, v3
    s_lshl2_add_u32 s78, s64, s35
    s_lshl_b32 s78, s78, 15
    v_lshlrev_b32 v2, 10, v2
    v_lshl_add_u32 v2, v3, 4, v2
    v_add_u32 v24, s78, v2
    v_add_u32 v25, 7152, v24
    v_add_u32 v26, 14304, v24
    v_add_u32 v27, 21456, v24
    s_mul_i32 s74, s35, 16576
    s_add_u32 s74, s74, 48384
    s_lshr_b32 s72, s37, 3
    s_add_u32 s72, s72, s69
    s_and_b32 s72, s72, 3
    s_lshl_b32 s72, s72, 1
    v_lshrrev_b32 v2, 5, v1
    v_and_b32 v3, 31, v1
    s_lshl2_add_u32 s78, s66, s35
    s_lshl_b32 s78, s78, 11
    v_lshlrev_b32 v2, 10, v2
    v_lshl_add_u32 v2, v3, 4, v2
    v_add_u32 v2, s78, v2
    v_mov_b32 v3, 0
    s_mov_b32 s42, 2097152
    s_mov_b32 s43, 0x20000
    s_waitcnt lgkmcnt(0)
    s_mov_b32 s40, s4
    s_mov_b32 s41, s5
    global_load_dwordx4 v[8:11], v2, s[4:5]
    global_load_dwordx4 v[12:15], v2, s[4:5] offset:512
    global_load_dword v6, v3, s[32:33] sc1
    s_add_u32 s76, s72, 0
    s_and_b32 s76, s76, 7
    s_mul_i32 s77, s76, 176128
    s_lshl_b32 s76, s76, 7
    s_add_u32 m0, s74, 0
    s_nop 0
    buffer_load_dwordx4 v24, s[40:43], s76 offen offset:0 lds
    buffer_load_dwordx4 v25, s[40:43], s76 offen offset:1040 lds
    buffer_load_dwordx4 v26, s[40:43], s76 offen offset:2080 lds
    buffer_load_dwordx4 v27, s[40:43], s76 offen offset:3120 lds
    s_and_b32 s78, s36, 1
    s_sub_u32 s79, 6, s78
    s_mul_i32 s70, s69, 3
    s_mul_i32 s78, s78, 22
    s_add_u32 s70, s70, s78
    s_cmp_lt_u32 s69, s79
    s_cselect_b32 s71, 12, 8
    s_max_u32 s78, s69, s79
    s_sub_u32 s78, s78, s79
    s_sub_u32 s70, s70, s78
    s_mul_i32 s78, s35, 192
    s_lshl_b32 s79, s70, 6
    s_mul_i32 s75, s35, 3072
    s_add_u32 s75, s75, 114688
    v_mov_b32 v5, 1073741824
    s_mov_b32 s44, s20
    s_mov_b32 s45, s21
    s_mov_b32 s46, 1409024
    s_mov_b32 s47, 0x20000
    v_add_u32 v2, s78, v1
    v_mul_u32_u24 v3, 43691, v2
    v_lshrrev_b32 v3, 19, v3
    v_mul_u32_u24 v4, 12, v3
    v_sub_u32 v4, v2, v4
    v_mul_u32_u24 v3, 2752, v3
    v_cmp_gt_u32 vcc, s71, v4
    v_lshl_add_u32 v3, v4, 4, v3
    v_add_u32 v3, s79, v3
    v_cndmask_b32 v28, v5, v3, vcc
    s_add_u32 s78, s78, 64
    s_sub_u32 s79, s79, 1024
    s_add_u32 m0, s75, 0
    s_nop 0
    buffer_load_dwordx4 v28, s[44:47], s77 offen offset:0 lds
    v_add_u32 v2, s78, v1
    v_mul_u32_u24 v3, 43691, v2
    v_lshrrev_b32 v3, 19, v3
    v_mul_u32_u24 v4, 12, v3
    v_sub_u32 v4, v2, v4
    v_mul_u32_u24 v3, 2752, v3
    v_cmp_gt_u32 vcc, s71, v4
    v_lshl_add_u32 v3, v4, 4, v3
    v_add_u32 v3, s79, v3
    v_cndmask_b32 v29, v5, v3, vcc
    s_add_u32 s78, s78, 64
    s_sub_u32 s79, s79, 1024
    buffer_load_dwordx4 v29, s[44:47], s77 offen offset:1024 lds
    v_add_u32 v2, s78, v1
    v_mul_u32_u24 v3, 43691, v2
    v_lshrrev_b32 v3, 19, v3
    v_mul_u32_u24 v4, 12, v3
    v_sub_u32 v4, v2, v4
    v_mul_u32_u24 v3, 2752, v3
    v_cmp_gt_u32 vcc, s71, v4
    v_lshl_add_u32 v3, v4, 4, v3
    v_add_u32 v3, s79, v3
    v_cndmask_b32 v30, v5, v3, vcc
    buffer_load_dwordx4 v30, s[44:47], s77 offen offset:2048 lds
    s_add_u32 s76, s72, 1
    s_and_b32 s76, s76, 7
    s_mul_i32 s77, s76, 176128
    s_lshl_b32 s76, s76, 7
    s_add_u32 m0, s74, 4144
    s_nop 0
    buffer_load_dwordx4 v24, s[40:43], s76 offen offset:0 lds
    buffer_load_dwordx4 v25, s[40:43], s76 offen offset:1040 lds
    s_mov_b32 s52, s32
    s_mov_b32 s53, s33
    s_mov_b32 s54, 10878976
    s_mov_b32 s55, 0x20000
    s_mov_b32 s48, s24
    s_mov_b32 s49, s25
    s_mov_b32 s50, 1409024
    s_mov_b32 s51, 0x20000
    s_mov_b32 s56, s28
    s_mov_b32 s57, s29
    s_mov_b32 s58, 2097152
    s_mov_b32 s59, 0x20000
    s_and_b32 s83, s35, 1
    s_lshr_b32 s84, s35, 1
    v_lshrrev_b32 v2, 3, v1
    v_and_b32 v3, 7, v1
    v_bfe_u32 v4, v1, 4, 1
    v_lshlrev_b32 v4, 2, v4
    v_xor_b32 v3, v3, v4
    v_lshlrev_b32 v2, 10, v2
    v_lshl_add_u32 v2, v3, 4, v2
    s_mul_i32 s78, s84, 704512
    s_lshl_b32 s79, s83, 13
    s_add_u32 s78, s78, s79
    s_lshl_b32 s79, s69, 7
    s_add_u32 s78, s78, s79
    v_add_u32 v18, s78, v2
    s_mul_i32 s85, s84, 57344
    s_lshl_b32 s79, s83, 10
    s_add_u32 s85, s85, s79
    s_add_u32 s85, s85, 48384
    s_mul_i32 s89, s69, 43
    s_lshr_b32 s89, s89, 3
    s_add_u32 s86, s89, 0
    s_cmp_ge_u32 s86, 43
    s_cselect_b32 s78, 43, 0
    s_sub_u32 s86, s86, s78
    s_lshl_b32 s86, s86, 14
    s_mov_b32 s88, 0
    s_cmp_eq_u32 s35, 3
    s_cselect_b32 s80, 0, s35
    s_add_u32 s81, s80, 1
    s_cmp_eq_u32 s81, 3
    s_cselect_b32 s81, 0, s81
    s_add_u32 s82, s81, 1
    s_cmp_eq_u32 s82, 3
    s_cselect_b32 s82, 0, s82
    v_and_b32 v2, 31, v1
    v_lshrrev_b32 v3, 5, v1
    s_lshl1_add_u32 s78, s69, s84
    s_lshl_b32 s78, s78, 6
    v_lshl_add_u32 v171, v3, 3, s78
    s_add_u32 s78, s70, s80
    s_lshl_b32 s78, s78, 6
    v_lshl_add_u32 v41, v2, 1, s78
    s_lshl2_add_u32 s78, s64, s35
    s_lshl_b32 s78, s78, 9
    s_add_u32 s78, s78, 131072
    v_lshl_add_u32 v42, v2, 4, s78
    s_lshl_b32 s78, s80, 7
    v_lshl_add_u32 v159, v2, 2, s78
    v_bfe_u32 v4, v1, 1, 3
    v_lshrrev_b32 v5, 3, v2
    v_mul_u32_u24 v40, 1040, v5
    v_bfe_u32 v5, v1, 2, 1
    v_lshl_add_u32 v40, v5, 9, v40
    v_and_b32 v5, 3, v1
    v_lshl_add_u32 v40, v5, 6, v40
    v_lshl_add_u32 v40, v3, 4, v40
    v_add_u32 v40, s74, v40
    v_lshlrev_b32 v2, 7, v2
    s_lshl_b32 s79, s84, 2
    v_xor_b32 v4, s79, v4
    v_lshl_add_u32 v2, v4, 4, v2
    v_lshl_add_u32 v2, v3, 3, v2
    s_lshl_b32 s79, s83, 12
    s_add_u32 s79, s79, 13056
    v_add_u32 v20, s79, v2
    v_and_b32 v2, 15, v1
    v_lshrrev_b32 v4, 4, v1
    v_lshlrev_b32 v4, 4, v4
    v_lshl_add_u32 v4, v2, 6, v4
    v_add_u32 v158, s78, v4
    v_add_u32 v158, 136448, v158
    s_lshr_b32 s78, s68, 1
    s_lshl_b32 s78, s78, 11
    s_add_u32 s78, s78, 36864
    v_lshl_add_u32 v19, v2, 7, s78
    v_bfe_u32 v4, v1, 4, 1
    v_cmp_eq_u32 vcc, v2, v4
    v_mov_b32 v5, 0x3f803f80
    v_mov_b32 v7, 0
    v_cndmask_b32 v48, 0, v5, vcc
    v_cndmask_b32 v49, 0, v5, vcc
    v_cndmask_b32 v50, 0, v5, vcc
    v_cndmask_b32 v51, 0, v5, vcc
    v_and_b32 v2, 3, v1
    v_lshlrev_b32 v2, 3, v2
    v_lshl_add_u32 v2, v4, 5, v2
    v_bfe_u32 v4, v1, 2, 2
    v_lshl_add_u32 v5, v3, 3, v4
    v_mul_u32_u24 v5, 192, v5
    v_add3_u32 v5, v5, v2, v7
    v_add_u32 v5, 114688, v5
    s_lshl_b32 s78, s80, 6
    v_add_u32 v44, s78, v5
    s_lshl_b32 s78, s80, 7
    v_lshl_add_u32 v43, v3, 4, s78
    s_lshl_b32 s78, s81, 6
    v_add_u32 v45, s78, v5
    s_lshl_b32 s78, s81, 7
    v_lshl_add_u32 v156, v3, 4, s78
    s_lshl_b32 s78, s82, 6
    v_add_u32 v46, s78, v5
    s_lshl_b32 s78, s82, 7
    v_lshl_add_u32 v157, v3, 4, s78
    v_lshl_add_u32 v5, v3, 2, v4
    v_mul_u32_u24 v21, 192, v5
    v_add_u32 v21, v21, v2
    s_mul_i32 s78, s84, 6144
    s_lshl_b32 s79, s83, 6
    s_add_u32 s78, s78, s79
    v_add_u32 v21, s78, v21
    v_lshl_add_u32 v5, v5, 7, v2
    v_lshrrev_b32 v4, 1, v4
    v_xor_b32 v4, s84, v4
    v_lshl_add_u32 v5, v4, 6, v5
    s_mul_i32 s79, s84, 57344
    s_add_u32 s78, s79, 48384
    v_add_u32 v34, s78, v5
    v_xor_b32 v35, 64, v34
    v_lshlrev_b32 v17, 4, v1
    s_lshl_b32 s78, s83, 12
    s_add_u32 s78, s78, 79104
    s_add_u32 s3, s78, s79
    v_add_u32 v32, s3, v17
    s_sub_u32 s79, 57344, s79
    s_add_u32 s3, s78, s79
    v_add_u32 v33, s3, v17
    s_lshl_b32 s78, s84, 2
    v_and_b32 v2, 3, v1
    v_or_b32 v2, s78, v2
    v_lshrrev_b32 v4, 3, v1
    v_xor_b32 v4, v4, v2
    v_lshrrev_b32 v5, 2, v1
    v_lshlrev_b32 v22, 7, v5
    v_lshl_add_u32 v22, v4, 4, v22
    s_lshl_b32 s79, s83, 12
    s_add_u32 s79, s79, 13056
    v_add_u32 v22, s79, v22
    s_lshl1_add_u32 s87, s68, s83
    s_lshl_b32 s78, s87, 15
    s_lshl_b32 s79, s69, 7
    s_add_u32 s78, s78, s79
    v_lshlrev_b32 v5, 10, v5
    v_lshl_add_u32 v5, v2, 4, v5
    v_add_u32 v23, s78, v5
    s_mul_i32 s87, s87, 86
    s_mul_i32 s79, s84, 43
    s_add_u32 s87, s87, s79
    s_lshl_b32 s87, s87, 10
    s_add_u32 s87, s87, 5242880
    s_mul_i32 s78, s37, 44032
    s_mul_i32 s79, s35, 11136
    s_add_u32 s78, s78, s79
    v_lshlrev_b32 v160, 7, v1
    v_add_u32 v160, s78, v160
    v_cmp_gt_u32 vcc, 29, v1
    v_mov_b32 v2, 1073741824
    s_lshl_b32 s78, s35, 2
    v_cndmask_b32 v160, v2, v160, vcc
    v_lshlrev_b32 v16, 2, v1
    v_add_u32 v16, 448, v16
    v_writelane_b32 v16, s78, 0
    s_mov_b32 s60, 0xffff0000
    s_mov_b32 s61, 0x3f803f80
    s_mov_b32 s62, 989855744
    s_mov_b32 s63, 925353388
    v_lshrrev_b32 v108, 5, v1
    s_lshl_b32 s78, s35, 1
    s_sub_u32 s78, 7, s78
    v_sub_u32 v108, s78, v108
    v_mul_u32_u24 v108, 1088, v108
    v_and_b32 v109, 31, v1
    v_lshl_add_u32 v113, v109, 4, v108
    s_barrier
    s_waitcnt vmcnt(10)
    v_mov_b32 v108, 0
    v_dot2_f32_bf16 v108, v8, s61, v108
    v_dot2_f32_bf16 v108, v9, s61, v108
    v_dot2_f32_bf16 v108, v10, s61, v108
    v_dot2_f32_bf16 v108, v11, s61, v108
    v_dot2_f32_bf16 v108, v12, s61, v108
    v_dot2_f32_bf16 v108, v13, s61, v108
    v_dot2_f32_bf16 v108, v14, s61, v108
    v_dot2_f32_bf16 v108, v15, s61, v108
    v_lshlrev_b32 v116, 16, v8
    v_and_b32 v117, s60, v8
    v_lshlrev_b32 v118, 16, v9
    v_and_b32 v119, s60, v9
    v_lshlrev_b32 v120, 16, v10
    v_and_b32 v121, s60, v10
    v_lshlrev_b32 v122, 16, v11
    v_and_b32 v123, s60, v11
    v_lshlrev_b32 v124, 16, v12
    v_and_b32 v125, s60, v12
    v_lshlrev_b32 v126, 16, v13
    v_and_b32 v127, s60, v13
    v_lshlrev_b32 v128, 16, v14
    v_and_b32 v129, s60, v14
    v_lshlrev_b32 v130, 16, v15
    v_and_b32 v131, s60, v15
    v_add_f32_dpp v108, v108, v108 quad_perm:[1,0,3,2] row_mask:0xf bank_mask:0xf
    s_nop 1
    v_add_f32_dpp v108, v108, v108 quad_perm:[2,3,0,1] row_mask:0xf bank_mask:0xf
    s_nop 1
    v_add_f32_dpp v108, v108, v108 row_half_mirror row_mask:0xf bank_mask:0xf
    s_nop 1
    v_add_f32_dpp v108, v108, v108 row_mirror row_mask:0xf bank_mask:0xf
    v_mov_b32 v110, v108
    s_nop 1
    v_permlane16_swap_b32 v108, v110
    v_add_f32 v108, v108, v110
    v_mul_f32 v108, s62, v108
    v_cvt_pk_bf16_f32 v114, v108, v108
    v_lshlrev_b32 v114, 16, v114
    v_pk_add_f32 v[116:117], v[116:117], v[114:115] op_sel_hi:[1,0] neg_lo:[0,1] neg_hi:[0,1]
    v_pk_add_f32 v[118:119], v[118:119], v[114:115] op_sel_hi:[1,0] neg_lo:[0,1] neg_hi:[0,1]
    v_pk_add_f32 v[120:121], v[120:121], v[114:115] op_sel_hi:[1,0] neg_lo:[0,1] neg_hi:[0,1]
    v_pk_add_f32 v[122:123], v[122:123], v[114:115] op_sel_hi:[1,0] neg_lo:[0,1] neg_hi:[0,1]
    v_pk_add_f32 v[124:125], v[124:125], v[114:115] op_sel_hi:[1,0] neg_lo:[0,1] neg_hi:[0,1]
    v_pk_add_f32 v[126:127], v[126:127], v[114:115] op_sel_hi:[1,0] neg_lo:[0,1] neg_hi:[0,1]
    v_pk_add_f32 v[128:129], v[128:129], v[114:115] op_sel_hi:[1,0] neg_lo:[0,1] neg_hi:[0,1]
    v_pk_add_f32 v[130:131], v[130:131], v[114:115] op_sel_hi:[1,0] neg_lo:[0,1] neg_hi:[0,1]
    v_pk_mul_f32 v[132:133], v[116:117], v[116:117]
    v_pk_fma_f32 v[132:133], v[118:119], v[118:119], v[132:133]
    v_pk_fma_f32 v[132:133], v[120:121], v[120:121], v[132:133]
    v_pk_fma_f32 v[132:133], v[122:123], v[122:123], v[132:133]
    v_pk_fma_f32 v[132:133], v[124:125], v[124:125], v[132:133]
    v_pk_fma_f32 v[132:133], v[126:127], v[126:127], v[132:133]
    v_pk_fma_f32 v[132:133], v[128:129], v[128:129], v[132:133]
    v_pk_fma_f32 v[132:133], v[130:131], v[130:131], v[132:133]
    v_add_f32 v110, v132, v133
    v_cvt_pk_bf16_f32 v8, v116, v117
    v_cvt_pk_bf16_f32 v9, v118, v119
    v_cvt_pk_bf16_f32 v10, v120, v121
    v_cvt_pk_bf16_f32 v11, v122, v123
    v_cvt_pk_bf16_f32 v12, v124, v125
    v_cvt_pk_bf16_f32 v13, v126, v127
    v_cvt_pk_bf16_f32 v14, v128, v129
    v_cvt_pk_bf16_f32 v15, v130, v131
    v_add_f32_dpp v110, v110, v110 quad_perm:[1,0,3,2] row_mask:0xf bank_mask:0xf
    s_nop 1
    v_add_f32_dpp v110, v110, v110 quad_perm:[2,3,0,1] row_mask:0xf bank_mask:0xf
    s_nop 1
    v_add_f32_dpp v110, v110, v110 row_half_mirror row_mask:0xf bank_mask:0xf
    s_nop 1
    v_add_f32_dpp v110, v110, v110 row_mirror row_mask:0xf bank_mask:0xf
    v_mov_b32 v112, v110
    s_nop 1
    v_permlane16_swap_b32 v110, v112
    v_add_f32 v110, v110, v112
    v_lshlrev_b32 v116, 16, v8
    v_and_b32 v117, s60, v8
    v_lshlrev_b32 v118, 16, v9
    v_and_b32 v119, s60, v9
    v_lshlrev_b32 v120, 16, v10
    v_and_b32 v121, s60, v10
    v_lshlrev_b32 v122, 16, v11
    v_and_b32 v123, s60, v11
    v_lshlrev_b32 v124, 16, v12
    v_and_b32 v125, s60, v12
    v_lshlrev_b32 v126, 16, v13
    v_and_b32 v127, s60, v13
    v_lshlrev_b32 v128, 16, v14
    v_and_b32 v129, s60, v14
    v_lshlrev_b32 v130, 16, v15
    v_and_b32 v131, s60, v15
    v_sub_f32 v108, v108, v114
    v_mul_f32 v108, v108, v108
    v_fma_f32 v112, v110, s62, -v108
    v_max_f32 v112, 0, v112
    v_cvt_pk_bf16_f32 v112, v112, v112
    v_lshlrev_b32 v112, 16, v112
    v_add_f32 v112, s63, v112
    v_cvt_pk_bf16_f32 v112, v112, v112
    v_lshlrev_b32 v112, 16, v112
    v_sqrt_f32 v112, v112
    s_nop 0
    v_cvt_pk_bf16_f32 v112, v112, v112
    v_lshlrev_b32 v112, 16, v112
    v_rcp_f32 v132, v112
    s_nop 0
    v_pk_mul_f32 v[116:117], v[116:117], v[132:133] op_sel_hi:[1,0]
    v_pk_mul_f32 v[118:119], v[118:119], v[132:133] op_sel_hi:[1,0]
    v_pk_mul_f32 v[120:121], v[120:121], v[132:133] op_sel_hi:[1,0]
    v_pk_mul_f32 v[122:123], v[122:123], v[132:133] op_sel_hi:[1,0]
    v_pk_mul_f32 v[124:125], v[124:125], v[132:133] op_sel_hi:[1,0]
    v_pk_mul_f32 v[126:127], v[126:127], v[132:133] op_sel_hi:[1,0]
    v_pk_mul_f32 v[128:129], v[128:129], v[132:133] op_sel_hi:[1,0]
    v_pk_mul_f32 v[130:131], v[130:131], v[132:133] op_sel_hi:[1,0]
    v_cvt_pk_bf16_f32 v8, v116, v117
    v_cvt_pk_bf16_f32 v9, v118, v119
    v_cvt_pk_bf16_f32 v10, v120, v121
    v_cvt_pk_bf16_f32 v11, v122, v123
    v_cvt_pk_bf16_f32 v12, v124, v125
    v_cvt_pk_bf16_f32 v13, v126, v127
    v_cvt_pk_bf16_f32 v14, v128, v129
    v_cvt_pk_bf16_f32 v15, v130, v131
    ds_write_b128 v113, v[8:11] offset:5856
    ds_write_b128 v113, v[12:15] offset:6368
    s_waitcnt vmcnt(9)
    v_add_u32 v6, 2654435769, v6
    s_nop 0
    v_readfirstlane_b32 s73, v6
    ds_write_b32 v7, v6 offset:44
    v_mov_b32 v108, 1
    ds_write_b32 v16, v108
    v_mov_b32 v108, 0
    v_mov_b32 v110, 0
    v_dot2_f32_bf16 v108, v8, s61, v108
    v_dot2_f32_bf16 v110, v8, v8, v110
    v_dot2_f32_bf16 v108, v9, s61, v108
    v_dot2_f32_bf16 v110, v9, v9, v110
    v_dot2_f32_bf16 v108, v10, s61, v108
    v_dot2_f32_bf16 v110, v10, v10, v110
    v_dot2_f32_bf16 v108, v11, s61, v108
    v_dot2_f32_bf16 v110, v11, v11, v110
    v_dot2_f32_bf16 v108, v12, s61, v108
    v_dot2_f32_bf16 v110, v12, v12, v110
    v_dot2_f32_bf16 v108, v13, s61, v108
    v_dot2_f32_bf16 v110, v13, v13, v110
    v_dot2_f32_bf16 v108, v14, s61, v108
    v_dot2_f32_bf16 v110, v14, v14, v110
    v_dot2_f32_bf16 v108, v15, s61, v108
    v_dot2_f32_bf16 v110, v15, v15, v110
    s_nop 1
    v_add_f32_dpp v108, v108, v108 quad_perm:[1,0,3,2] row_mask:0xf bank_mask:0xf
    v_add_f32_dpp v110, v110, v110 quad_perm:[1,0,3,2] row_mask:0xf bank_mask:0xf
    s_nop 0
    v_add_f32_dpp v108, v108, v108 quad_perm:[2,3,0,1] row_mask:0xf bank_mask:0xf
    v_add_f32_dpp v110, v110, v110 quad_perm:[2,3,0,1] row_mask:0xf bank_mask:0xf
    s_nop 0
    v_add_f32_dpp v108, v108, v108 row_half_mirror row_mask:0xf bank_mask:0xf
    v_add_f32_dpp v110, v110, v110 row_half_mirror row_mask:0xf bank_mask:0xf
    s_nop 0
    v_add_f32_dpp v108, v108, v108 row_mirror row_mask:0xf bank_mask:0xf
    v_add_f32_dpp v110, v110, v110 row_mirror row_mask:0xf bank_mask:0xf
    v_mov_b32 v109, v108
    v_mov_b32 v111, v110
    s_nop 0
    v_permlane16_swap_b32 v108, v109
    v_permlane16_swap_b32 v110, v111
    v_add_f32 v108, v108, v109
    v_add_f32 v110, v110, v111
    v_mul_f32 v108, s62, v108
    v_mul_f32 v109, v108, v108
    v_fma_f32 v110, v110, s62, -v109
    v_max_f32 v110, 0, v110
    v_cvt_pk_bf16_f32 v108, v108, v108
    v_lshlrev_b32 v108, 16, v108
    v_cvt_pk_bf16_f32 v110, v110, v110
    v_lshlrev_b32 v110, 16, v110
    v_add_f32 v110, s63, v110
    v_cvt_pk_bf16_f32 v110, v110, v110
    v_lshlrev_b32 v110, 16, v110
    v_sqrt_f32 v110, v110
    s_nop 0
    v_cvt_pk_bf16_f32 v110, v110, v110
    v_lshlrev_b32 v110, 16, v110
    v_rcp_f32 v110, v110
    v_mov_b32 v125, v6
    v_mov_b32 v127, v6
    v_mul_f32 v124, v132, v110
    v_mul_f32 v108, v108, v110
    v_fma_f32 v126, v114, v124, v108
    v_lshrrev_b32 v109, 5, v1
    s_lshl_b32 s78, s66, 7
    s_lshl_b32 s79, s35, 5
    s_add_u32 s78, s78, s79
    s_add_u32 s78, s78, 131072
    v_lshl_add_u32 v109, v109, 4, s78
    s_mov_b32 exec_lo, 1
    s_mov_b32 exec_hi, 1
    buffer_store_dwordx4 v[124:127], v109, s[52:55], 0 offen sc1
    s_mov_b64 exec, -1
    s_mov_b32 s60, s22
    s_mov_b32 s61, s23
    s_mov_b32 s62, 2752
    s_mov_b32 s63, 0x20000
    s_waitcnt vmcnt(6)
    buffer_load_dwordx4 v26, s[40:43], s76 offen offset:2080 lds
    s_waitcnt vmcnt(6)
    buffer_load_dwordx4 v27, s[40:43], s76 offen offset:3120 lds
    s_add_u32 m0, s75, 12288
    s_waitcnt vmcnt(6)
    buffer_load_dwordx4 v28, s[44:47], s77 offen offset:0 lds
    s_waitcnt vmcnt(6)
    buffer_load_dwordx4 v29, s[44:47], s77 offen offset:1024 lds
    s_waitcnt vmcnt(6)
    buffer_load_dwordx4 v30, s[44:47], s77 offen offset:2048 lds
    buffer_load_ushort v41, v41, s[60:63], 0 offen
    global_load_dwordx2 v[164:165], v171, s[26:27] offset:0
    global_load_dwordx2 v[166:167], v171, s[26:27] offset:16
    global_load_dwordx2 v[168:169], v171, s[26:27] offset:32
    global_load_dwordx2 v[170:171], v171, s[26:27] offset:48
    s_waitcnt vmcnt(13)
    v_mov_b32 v2, 2
    ds_write_b32 v16, v2
    ds_read_b128 v[36:39], v7 offset:0
    s_waitcnt lgkmcnt(0)
L_chk_1:
    v_min3_u32 v36, v36, v37, v38
    v_min_u32 v36, v36, v39
    v_cmp_gt_u32 vcc, 2, v36
    s_cbranch_vccnz L_slow_2
    ds_read_b128 v[108:111], v40 offset:0
    ds_read_b64_tr_b16 v[112:113], v44 offset:0
    ds_read_b64_tr_b16 v[114:115], v44 offset:768
    ds_read_b64_tr_b16 v[116:117], v45 offset:0
    ds_read_b64_tr_b16 v[118:119], v45 offset:768
    ds_read_b64_tr_b16 v[120:121], v46 offset:0
    ds_read_b64_tr_b16 v[122:123], v46 offset:768
    ds_read_b128 v[124:127], v40 offset:32
    ds_read_b64_tr_b16 v[128:129], v44 offset:3072
    ds_read_b64_tr_b16 v[130:131], v44 offset:3840
    ds_read_b64_tr_b16 v[132:133], v45 offset:3072
    ds_read_b64_tr_b16 v[134:135], v45 offset:3840
    ds_read_b64_tr_b16 v[136:137], v46 offset:3072
    ds_read_b64_tr_b16 v[138:139], v46 offset:3840
    s_waitcnt lgkmcnt(11)
    v_mfma_f32_32x32x16_bf16 v[56:71], v[112:115], v[108:111], 0
    ds_read_b128 v[140:143], v40 offset:256
    ds_read_b64_tr_b16 v[144:145], v44 offset:6144
    ds_read_b64_tr_b16 v[146:147], v44 offset:6912
    s_add_u32 s76, s72, 2
    s_and_b32 s76, s76, 7
    s_mul_i32 s77, s76, 176128
    s_lshl_b32 s76, s76, 7
    s_add_u32 m0, s74, 8288
    s_nop 0
    buffer_load_dwordx4 v24, s[40:43], s76 offen offset:0 lds
    v_mfma_f32_16x16x32_bf16 v[104:107], v[112:115], v[48:51], 0
    ds_read_b64_tr_b16 v[148:149], v45 offset:6144
    buffer_load_dwordx4 v25, s[40:43], s76 offen offset:1040 lds
    s_waitcnt lgkmcnt(11)
    v_mfma_f32_32x32x16_bf16 v[72:87], v[116:119], v[108:111], 0
    ds_read_b64_tr_b16 v[150:151], v45 offset:6912
    ds_read_b64_tr_b16 v[152:153], v46 offset:6144
    buffer_load_dwordx4 v26, s[40:43], s76 offen offset:2080 lds
    s_waitcnt vmcnt(8)
    v_mov_b32 v2, 3
    ds_write_b32 v16, v2
    v_mfma_f32_32x32x16_bf16 v[88:103], v[120:123], v[108:111], 0
    ds_read_b64_tr_b16 v[154:155], v46 offset:6912
    buffer_load_dwordx4 v27, s[40:43], s76 offen offset:3120 lds
    s_waitcnt lgkmcnt(12)
    v_mfma_f32_32x32x16_bf16 v[56:71], v[128:131], v[124:127], v[56:71]
    ds_read_b128 v[108:111], v40 offset:288
    ds_read_b64_tr_b16 v[112:113], v44 offset:9216
    ds_read_b64_tr_b16 v[114:115], v44 offset:9984
    v_mfma_f32_16x16x32_bf16 v[104:107], v[128:131], v[48:51], v[104:107]
    ds_read_b64_tr_b16 v[116:117], v45 offset:9216
    s_add_u32 m0, s75, 24576
    s_nop 0
    buffer_load_dwordx4 v28, s[44:47], s77 offen offset:0 lds
    s_waitcnt lgkmcnt(12)
    v_mfma_f32_32x32x16_bf16 v[72:87], v[132:135], v[124:127], v[72:87]
    ds_read_b64_tr_b16 v[118:119], v45 offset:9984
    ds_read_b64_tr_b16 v[120:121], v46 offset:9216
    buffer_load_dwordx4 v29, s[44:47], s77 offen offset:1024 lds
    ds_read_b128 v[36:39], v7 offset:0
    v_mfma_f32_32x32x16_bf16 v[88:103], v[136:139], v[124:127], v[88:103]
    ds_read_b64_tr_b16 v[122:123], v46 offset:9984
    buffer_load_dwordx4 v30, s[44:47], s77 offen offset:2048 lds
    s_waitcnt lgkmcnt(13)
    v_mfma_f32_32x32x16_bf16 v[56:71], v[144:147], v[140:143], v[56:71]
    s_waitcnt lgkmcnt(1)
L_chk_3:
    v_min3_u32 v36, v36, v37, v38
    v_min_u32 v36, v36, v39
    v_cmp_gt_u32 vcc, 3, v36
    s_cbranch_vccnz L_slow_4
    s_add_u32 s76, s72, 3
    s_and_b32 s76, s76, 7
    s_mul_i32 s77, s76, 176128
    s_lshl_b32 s76, s76, 7
    s_add_u32 m0, s74, 12432
    s_nop 0
    buffer_load_dwordx4 v24, s[40:43], s76 offen offset:0 lds
    v_mfma_f32_16x16x32_bf16 v[104:107], v[144:147], v[48:51], v[104:107]
    ds_read_b128 v[124:127], v40 offset:4144
    buffer_load_dwordx4 v25, s[40:43], s76 offen offset:1040 lds
    s_waitcnt lgkmcnt(9)
    v_mfma_f32_32x32x16_bf16 v[72:87], v[148:151], v[140:143], v[72:87]
    ds_read_b64_tr_b16 v[128:129], v44 offset:12288
    ds_read_b64_tr_b16 v[130:131], v44 offset:13056
    ds_read_b64_tr_b16 v[132:133], v45 offset:12288
    buffer_load_dwordx4 v26, s[40:43], s76 offen offset:2080 lds
    v_mfma_f32_32x32x16_bf16 v[88:103], v[152:155], v[140:143], v[88:103]
    ds_read_b64_tr_b16 v[134:135], v45 offset:13056
    ds_read_b64_tr_b16 v[136:137], v46 offset:12288
    ds_read_b64_tr_b16 v[138:139], v46 offset:13056
    buffer_load_dwordx4 v27, s[40:43], s76 offen offset:3120 lds
    s_waitcnt lgkmcnt(12)
    v_mfma_f32_32x32x16_bf16 v[56:71], v[112:115], v[108:111], v[56:71]
    ds_read_b128 v[140:143], v40 offset:4176
    ds_read_b64_tr_b16 v[144:145], v44 offset:15360
    ds_read_b64_tr_b16 v[146:147], v44 offset:16128
    v_mfma_f32_16x16x32_bf16 v[104:107], v[112:115], v[48:51], v[104:107]
    ds_read_b64_tr_b16 v[148:149], v45 offset:15360
    s_add_u32 m0, s75, 36864
    s_nop 0
    buffer_load_dwordx4 v28, s[44:47], s77 offen offset:0 lds
    s_waitcnt lgkmcnt(11)
    v_mfma_f32_32x32x16_bf16 v[72:87], v[116:119], v[108:111], v[72:87]
    ds_read_b64_tr_b16 v[150:151], v45 offset:16128
    ds_read_b64_tr_b16 v[152:153], v46 offset:15360
    buffer_load_dwordx4 v29, s[44:47], s77 offen offset:1024 lds
    v_mfma_f32_32x32x16_bf16 v[88:103], v[120:123], v[108:111], v[88:103]
    ds_read_b64_tr_b16 v[154:155], v46 offset:16128
    buffer_load_dwordx4 v30, s[44:47], s77 offen offset:2048 lds
    s_waitcnt lgkmcnt(11)
    v_mfma_f32_32x32x16_bf16 v[56:71], v[128:131], v[124:127], v[56:71]
    ds_read_b128 v[108:111], v40 offset:4400
    ds_read_b64_tr_b16 v[112:113], v44 offset:18432
    ds_read_b64_tr_b16 v[114:115], v44 offset:19200
    v_mfma_f32_16x16x32_bf16 v[104:107], v[128:131], v[48:51], v[104:107]
    ds_read_b64_tr_b16 v[116:117], v45 offset:18432
    s_add_u32 s76, s72, 4
    s_and_b32 s76, s76, 7
    s_mul_i32 s77, s76, 176128
    s_lshl_b32 s76, s76, 7
    s_add_u32 m0, s74, 0
    s_nop 0
    buffer_load_dwordx4 v24, s[40:43], s76 offen offset:0 lds
    s_waitcnt lgkmcnt(11)
    v_mfma_f32_32x32x16_bf16 v[72:87], v[132:135], v[124:127], v[72:87]
    ds_read_b64_tr_b16 v[118:119], v45 offset:19200
    ds_read_b64_tr_b16 v[120:121], v46 offset:18432
    s_waitcnt vmcnt(8)
    v_mov_b32 v2, 4
    ds_write_b32 v16, v2
    v_mfma_f32_32x32x16_bf16 v[88:103], v[136:139], v[124:127], v[88:103]
    ds_read_b64_tr_b16 v[122:123], v46 offset:19200
    buffer_load_dwordx4 v25, s[40:43], s76 offen offset:1040 lds
    s_waitcnt lgkmcnt(12)
    v_mfma_f32_32x32x16_bf16 v[56:71], v[144:147], v[140:143], v[56:71]
    ds_read_b128 v[124:127], v40 offset:4432
    ds_read_b64_tr_b16 v[128:129], v44 offset:21504
    ds_read_b64_tr_b16 v[130:131], v44 offset:22272
    v_mfma_f32_16x16x32_bf16 v[104:107], v[144:147], v[48:51], v[104:107]
    ds_read_b64_tr_b16 v[132:133], v45 offset:21504
    buffer_load_dwordx4 v26, s[40:43], s76 offen offset:2080 lds
    s_waitcnt lgkmcnt(12)
    v_mfma_f32_32x32x16_bf16 v[72:87], v[148:151], v[140:143], v[72:87]
    ds_read_b64_tr_b16 v[134:135], v45 offset:22272
    ds_read_b64_tr_b16 v[136:137], v46 offset:21504
    ds_read_b128 v[36:39], v7 offset:0
    v_mfma_f32_32x32x16_bf16 v[88:103], v[152:155], v[140:143], v[88:103]
    ds_read_b64_tr_b16 v[138:139], v46 offset:22272
    buffer_load_dwordx4 v27, s[40:43], s76 offen offset:3120 lds
    s_waitcnt lgkmcnt(13)
    v_mfma_f32_32x32x16_bf16 v[56:71], v[112:115], v[108:111], v[56:71]
    s_waitcnt lgkmcnt(1)
L_chk_5:
    v_min3_u32 v36, v36, v37, v38
    v_min_u32 v36, v36, v39
    v_cmp_gt_u32 vcc, 4, v36
    s_cbranch_vccnz L_slow_6
    v_mfma_f32_16x16x32_bf16 v[104:107], v[112:115], v[48:51], v[104:107]
    ds_read_b128 v[140:143], v40 offset:8288
    s_waitcnt lgkmcnt(9)
    v_mfma_f32_32x32x16_bf16 v[72:87], v[116:119], v[108:111], v[72:87]
    ds_read_b64_tr_b16 v[144:145], v44 offset:24576
    ds_read_b64_tr_b16 v[146:147], v44 offset:25344
    ds_read_b64_tr_b16 v[148:149], v45 offset:24576
    v_mfma_f32_32x32x16_bf16 v[88:103], v[120:123], v[108:111], v[88:103]
    ds_read_b64_tr_b16 v[150:151], v45 offset:25344
    ds_read_b64_tr_b16 v[152:153], v46 offset:24576
    ds_read_b64_tr_b16 v[154:155], v46 offset:25344
    s_add_u32 m0, s75, 0
    s_nop 0
    buffer_load_dwordx4 v28, s[44:47], s77 offen offset:0 lds
    s_waitcnt lgkmcnt(12)
    v_mfma_f32_32x32x16_bf16 v[56:71], v[128:131], v[124:127], v[56:71]
    ds_read_b128 v[108:111], v40 offset:8320
    ds_read_b64_tr_b16 v[112:113], v44 offset:27648
    ds_read_b64_tr_b16 v[114:115], v44 offset:28416
    v_mfma_f32_16x16x32_bf16 v[104:107], v[128:131], v[48:51], v[104:107]
    ds_read_b64_tr_b16 v[116:117], v45 offset:27648
    buffer_load_dwordx4 v29, s[44:47], s77 offen offset:1024 lds
    s_waitcnt lgkmcnt(11)
    v_mfma_f32_32x32x16_bf16 v[72:87], v[132:135], v[124:127], v[72:87]
    ds_read_b64_tr_b16 v[118:119], v45 offset:28416
    ds_read_b64_tr_b16 v[120:121], v46 offset:27648
    v_mfma_f32_32x32x16_bf16 v[88:103], v[136:139], v[124:127], v[88:103]
    ds_read_b64_tr_b16 v[122:123], v46 offset:28416
    buffer_load_dwordx4 v30, s[44:47], s77 offen offset:2048 lds
    s_waitcnt lgkmcnt(11)
    v_mfma_f32_32x32x16_bf16 v[56:71], v[144:147], v[140:143], v[56:71]
    ds_read_b128 v[124:127], v40 offset:8544
    ds_read_b64_tr_b16 v[128:129], v44 offset:30720
    ds_read_b64_tr_b16 v[130:131], v44 offset:31488
    v_mfma_f32_16x16x32_bf16 v[104:107], v[144:147], v[48:51], v[104:107]
    ds_read_b64_tr_b16 v[132:133], v45 offset:30720
    s_add_u32 s76, s72, 5
    s_and_b32 s76, s76, 7
    s_mul_i32 s77, s76, 176128
    s_lshl_b32 s76, s76, 7
    s_add_u32 m0, s74, 4144
    s_nop 0
    buffer_load_dwordx4 v24, s[40:43], s76 offen offset:0 lds
    s_waitcnt lgkmcnt(11)
    v_mfma_f32_32x32x16_bf16 v[72:87], v[148:151], v[140:143], v[72:87]
    ds_read_b64_tr_b16 v[134:135], v45 offset:31488
    ds_read_b64_tr_b16 v[136:137], v46 offset:30720
    s_waitcnt vmcnt(8)
    v_mov_b32 v2, 5
    ds_write_b32 v16, v2
    v_mfma_f32_32x32x16_bf16 v[88:103], v[152:155], v[140:143], v[88:103]
    ds_read_b64_tr_b16 v[138:139], v46 offset:31488
    buffer_load_dwordx4 v25, s[40:43], s76 offen offset:1040 lds
    v_lshlrev_b32 v41, 16, v41
    ds_write_b32 v159, v41 offset:64
    s_waitcnt lgkmcnt(13)
    v_mfma_f32_32x32x16_bf16 v[56:71], v[112:115], v[108:111], v[56:71]
    ds_read_b128 v[140:143], v40 offset:8576
    ds_read_b64_tr_b16 v[144:145], v44 offset:33792
    ds_read_b64_tr_b16 v[146:147], v44 offset:34560
    v_mfma_f32_16x16x32_bf16 v[104:107], v[112:115], v[48:51], v[104:107]
    ds_read_b64_tr_b16 v[148:149], v45 offset:33792
    buffer_load_dwordx4 v26, s[40:43], s76 offen offset:2080 lds
    s_waitcnt lgkmcnt(13)
    v_mfma_f32_32x32x16_bf16 v[72:87], v[116:119], v[108:111], v[72:87]
    ds_read_b64_tr_b16 v[150:151], v45 offset:34560
    ds_read_b64_tr_b16 v[152:153], v46 offset:33792
    ds_read_b128 v[36:39], v7 offset:0
    v_mfma_f32_32x32x16_bf16 v[88:103], v[120:123], v[108:111], v[88:103]
    ds_read_b64_tr_b16 v[154:155], v46 offset:34560
    buffer_load_dwordx4 v27, s[40:43], s76 offen offset:3120 lds
    s_waitcnt lgkmcnt(14)
    v_mfma_f32_32x32x16_bf16 v[56:71], v[128:131], v[124:127], v[56:71]
    s_waitcnt lgkmcnt(1)
L_chk_7:
    v_min3_u32 v36, v36, v37, v38
    v_min_u32 v36, v36, v39
    v_cmp_gt_u32 vcc, 5, v36
    s_cbranch_vccnz L_slow_8
    v_mfma_f32_16x16x32_bf16 v[104:107], v[128:131], v[48:51], v[104:107]
    ds_read_b128 v[108:111], v40 offset:12432
    s_waitcnt lgkmcnt(10)
    v_mfma_f32_32x32x16_bf16 v[72:87], v[132:135], v[124:127], v[72:87]
    ds_read_b64_tr_b16 v[112:113], v44 offset:36864
    ds_read_b64_tr_b16 v[114:115], v44 offset:37632
    ds_read_b64_tr_b16 v[116:117], v45 offset:36864
    v_mfma_f32_32x32x16_bf16 v[88:103], v[136:139], v[124:127], v[88:103]
    ds_read_b64_tr_b16 v[118:119], v45 offset:37632
    ds_read_b64_tr_b16 v[120:121], v46 offset:36864
    ds_read_b64_tr_b16 v[122:123], v46 offset:37632
    s_add_u32 m0, s75, 12288
    s_nop 0
    buffer_load_dwordx4 v28, s[44:47], s77 offen offset:0 lds
    s_waitcnt lgkmcnt(12)
    v_mfma_f32_32x32x16_bf16 v[56:71], v[144:147], v[140:143], v[56:71]
    ds_read_b128 v[124:127], v40 offset:12464
    ds_read_b64_tr_b16 v[128:129], v44 offset:39936
    ds_read_b64_tr_b16 v[130:131], v44 offset:40704
    v_mfma_f32_16x16x32_bf16 v[104:107], v[144:147], v[48:51], v[104:107]
    ds_read_b64_tr_b16 v[132:133], v45 offset:39936
    buffer_load_dwordx4 v29, s[44:47], s77 offen offset:1024 lds
    s_waitcnt lgkmcnt(11)
    v_mfma_f32_32x32x16_bf16 v[72:87], v[148:151], v[140:143], v[72:87]
    ds_read_b64_tr_b16 v[134:135], v45 offset:40704
    ds_read_b64_tr_b16 v[136:137], v46 offset:39936
    v_mfma_f32_32x32x16_bf16 v[88:103], v[152:155], v[140:143], v[88:103]
    ds_read_b64_tr_b16 v[138:139], v46 offset:40704
    buffer_load_dwordx4 v30, s[44:47], s77 offen offset:2048 lds
    s_waitcnt lgkmcnt(11)
    v_mfma_f32_32x32x16_bf16 v[56:71], v[112:115], v[108:111], v[56:71]
    ds_read_b128 v[140:143], v40 offset:12688
    ds_read_b64_tr_b16 v[144:145], v44 offset:43008
    ds_read_b64_tr_b16 v[146:147], v44 offset:43776
    v_mfma_f32_16x16x32_bf16 v[104:107], v[112:115], v[48:51], v[104:107]
    ds_read_b64_tr_b16 v[148:149], v45 offset:43008
    s_add_u32 s76, s72, 6
    s_and_b32 s76, s76, 7
    s_mul_i32 s77, s76, 176128
    s_lshl_b32 s76, s76, 7
    s_add_u32 m0, s74, 8288
    s_nop 0
    buffer_load_dwordx4 v24, s[40:43], s76 offen offset:0 lds
    s_waitcnt lgkmcnt(11)
    v_mfma_f32_32x32x16_bf16 v[72:87], v[116:119], v[108:111], v[72:87]
    ds_read_b64_tr_b16 v[150:151], v45 offset:43776
    ds_read_b64_tr_b16 v[152:153], v46 offset:43008
    s_waitcnt vmcnt(8)
    v_mov_b32 v2, 6
    ds_write_b32 v16, v2
    v_mfma_f32_32x32x16_bf16 v[88:103], v[120:123], v[108:111], v[88:103]
    ds_read_b64_tr_b16 v[154:155], v46 offset:43776
    buffer_load_dwordx4 v25, s[40:43], s76 offen offset:1040 lds
    s_waitcnt lgkmcnt(12)
    v_mfma_f32_32x32x16_bf16 v[56:71], v[128:131], v[124:127], v[56:71]
    ds_read_b128 v[108:111], v40 offset:12720
    ds_read_b64_tr_b16 v[112:113], v44 offset:46080
    ds_read_b64_tr_b16 v[114:115], v44 offset:46848
    v_mfma_f32_16x16x32_bf16 v[104:107], v[128:131], v[48:51], v[104:107]
    ds_read_b64_tr_b16 v[116:117], v45 offset:46080
    buffer_load_dwordx4 v26, s[40:43], s76 offen offset:2080 lds
    s_waitcnt lgkmcnt(12)
    v_mfma_f32_32x32x16_bf16 v[72:87], v[132:135], v[124:127], v[72:87]
    ds_read_b64_tr_b16 v[118:119], v45 offset:46848
    ds_read_b64_tr_b16 v[120:121], v46 offset:46080
    ds_read_b128 v[36:39], v7 offset:0
    v_mfma_f32_32x32x16_bf16 v[88:103], v[136:139], v[124:127], v[88:103]
    ds_read_b64_tr_b16 v[122:123], v46 offset:46848
    buffer_load_dwordx4 v27, s[40:43], s76 offen offset:3120 lds
    s_waitcnt lgkmcnt(13)
    v_mfma_f32_32x32x16_bf16 v[56:71], v[144:147], v[140:143], v[56:71]
    s_waitcnt lgkmcnt(1)
L_chk_9:
    v_min3_u32 v36, v36, v37, v38
    v_min_u32 v36, v36, v39
    v_cmp_gt_u32 vcc, 6, v36
    s_cbranch_vccnz L_slow_10
    v_mfma_f32_16x16x32_bf16 v[104:107], v[144:147], v[48:51], v[104:107]
    ds_read_b128 v[124:127], v40 offset:0
    s_waitcnt lgkmcnt(9)
    v_mfma_f32_32x32x16_bf16 v[72:87], v[148:151], v[140:143], v[72:87]
    ds_read_b64_tr_b16 v[128:129], v44 offset:0
    ds_read_b64_tr_b16 v[130:131], v44 offset:768
    ds_read_b64_tr_b16 v[132:133], v45 offset:0
    v_mfma_f32_32x32x16_bf16 v[88:103], v[152:155], v[140:143], v[88:103]
    ds_read_b64_tr_b16 v[134:135], v45 offset:768
    ds_read_b64_tr_b16 v[136:137], v46 offset:0
    ds_read_b64_tr_b16 v[138:139], v46 offset:768
    s_add_u32 m0, s75, 24576
    s_nop 0
    buffer_load_dwordx4 v28, s[44:47], s77 offen offset:0 lds
    s_waitcnt lgkmcnt(12)
    v_mfma_f32_32x32x16_bf16 v[56:71], v[112:115], v[108:111], v[56:71]
    ds_read_b128 v[140:143], v40 offset:32
    ds_read_b64_tr_b16 v[144:145], v44 offset:3072
    ds_read_b64_tr_b16 v[146:147], v44 offset:3840
    v_mfma_f32_16x16x32_bf16 v[104:107], v[112:115], v[48:51], v[104:107]
    ds_read_b64_tr_b16 v[148:149], v45 offset:3072
    buffer_load_dwordx4 v29, s[44:47], s77 offen offset:1024 lds
    s_waitcnt lgkmcnt(11)
    v_mfma_f32_32x32x16_bf16 v[72:87], v[116:119], v[108:111], v[72:87]
    ds_read_b64_tr_b16 v[150:151], v45 offset:3840
    ds_read_b64_tr_b16 v[152:153], v46 offset:3072
    v_mfma_f32_32x32x16_bf16 v[88:103], v[120:123], v[108:111], v[88:103]
    ds_read_b64_tr_b16 v[154:155], v46 offset:3840
    buffer_load_dwordx4 v30, s[44:47], s77 offen offset:2048 lds
    s_waitcnt lgkmcnt(11)
    v_mfma_f32_32x32x16_bf16 v[56:71], v[128:131], v[124:127], v[56:71]
    ds_read_b128 v[108:111], v40 offset:256
    ds_read_b64_tr_b16 v[112:113], v44 offset:6144
    ds_read_b64_tr_b16 v[114:115], v44 offset:6912
    v_mfma_f32_16x16x32_bf16 v[104:107], v[128:131], v[48:51], v[104:107]
    ds_read_b64_tr_b16 v[116:117], v45 offset:6144
    s_add_u32 s76, s72, 7
    s_and_b32 s76, s76, 7
    s_mul_i32 s77, s76, 176128
    s_lshl_b32 s76, s76, 7
    s_add_u32 m0, s74, 12432
    s_nop 0
    buffer_load_dwordx4 v24, s[40:43], s76 offen offset:0 lds
    s_waitcnt lgkmcnt(11)
    v_mfma_f32_32x32x16_bf16 v[72:87], v[132:135], v[124:127], v[72:87]
    ds_read_b64_tr_b16 v[118:119], v45 offset:6912
    ds_read_b64_tr_b16 v[120:121], v46 offset:6144
    s_waitcnt vmcnt(8)
    v_mov_b32 v2, 7
    ds_write_b32 v16, v2
    v_mfma_f32_32x32x16_bf16 v[88:103], v[136:139], v[124:127], v[88:103]
    ds_read_b64_tr_b16 v[122:123], v46 offset:6912
    buffer_load_dwordx4 v25, s[40:43], s76 offen offset:1040 lds
    s_waitcnt lgkmcnt(12)
    v_mfma_f32_32x32x16_bf16 v[56:71], v[144:147], v[140:143], v[56:71]
    ds_read_b128 v[124:127], v40 offset:288
    ds_read_b64_tr_b16 v[128:129], v44 offset:9216
    ds_read_b64_tr_b16 v[130:131], v44 offset:9984
    v_mfma_f32_16x16x32_bf16 v[104:107], v[144:147], v[48:51], v[104:107]
    ds_read_b64_tr_b16 v[132:133], v45 offset:9216
    buffer_load_dwordx4 v26, s[40:43], s76 offen offset:2080 lds
    s_waitcnt lgkmcnt(12)
    v_mfma_f32_32x32x16_bf16 v[72:87], v[148:151], v[140:143], v[72:87]
    ds_read_b64_tr_b16 v[134:135], v45 offset:9984
    ds_read_b64_tr_b16 v[136:137], v46 offset:9216
    ds_read_b128 v[36:39], v7 offset:0
    v_mfma_f32_32x32x16_bf16 v[88:103], v[152:155], v[140:143], v[88:103]
    ds_read_b64_tr_b16 v[138:139], v46 offset:9984
    buffer_load_dwordx4 v27, s[40:43], s76 offen offset:3120 lds
    s_waitcnt lgkmcnt(13)
    v_mfma_f32_32x32x16_bf16 v[56:71], v[112:115], v[108:111], v[56:71]
    s_waitcnt lgkmcnt(1)
L_chk_11:
    v_min3_u32 v36, v36, v37, v38
    v_min_u32 v36, v36, v39
    v_cmp_gt_u32 vcc, 7, v36
    s_cbranch_vccnz L_slow_12
    v_mfma_f32_16x16x32_bf16 v[104:107], v[112:115], v[48:51], v[104:107]
    ds_read_b128 v[140:143], v40 offset:4144
    s_waitcnt lgkmcnt(9)
    v_mfma_f32_32x32x16_bf16 v[72:87], v[116:119], v[108:111], v[72:87]
    ds_read_b64_tr_b16 v[144:145], v44 offset:12288
    ds_read_b64_tr_b16 v[146:147], v44 offset:13056
    ds_read_b64_tr_b16 v[148:149], v45 offset:12288
    v_mfma_f32_32x32x16_bf16 v[88:103], v[120:123], v[108:111], v[88:103]
    ds_read_b64_tr_b16 v[150:151], v45 offset:13056
    ds_read_b64_tr_b16 v[152:153], v46 offset:12288
    ds_read_b64_tr_b16 v[154:155], v46 offset:13056
    s_add_u32 m0, s75, 36864
    s_nop 0
    buffer_load_dwordx4 v28, s[44:47], s77 offen offset:0 lds
    s_waitcnt lgkmcnt(12)
    v_mfma_f32_32x32x16_bf16 v[56:71], v[128:131], v[124:127], v[56:71]
    ds_read_b128 v[108:111], v40 offset:4176
    ds_read_b64_tr_b16 v[112:113], v44 offset:15360
    ds_read_b64_tr_b16 v[114:115], v44 offset:16128
    v_mfma_f32_16x16x32_bf16 v[104:107], v[128:131], v[48:51], v[104:107]
    ds_read_b64_tr_b16 v[116:117], v45 offset:15360
    buffer_load_dwordx4 v29, s[44:47], s77 offen offset:1024 lds
    s_waitcnt lgkmcnt(11)
    v_mfma_f32_32x32x16_bf16 v[72:87], v[132:135], v[124:127], v[72:87]
    ds_read_b64_tr_b16 v[118:119], v45 offset:16128
    ds_read_b64_tr_b16 v[120:121], v46 offset:15360
    v_mfma_f32_32x32x16_bf16 v[88:103], v[136:139], v[124:127], v[88:103]
    ds_read_b64_tr_b16 v[122:123], v46 offset:16128
    buffer_load_dwordx4 v30, s[44:47], s77 offen offset:2048 lds
    s_waitcnt lgkmcnt(11)
    v_mfma_f32_32x32x16_bf16 v[56:71], v[144:147], v[140:143], v[56:71]
    ds_read_b128 v[124:127], v40 offset:4400
    ds_read_b64_tr_b16 v[128:129], v44 offset:18432
    ds_read_b64_tr_b16 v[130:131], v44 offset:19200
    buffer_load_dwordx4 v[52:55], v42, s[52:55], 0 offen sc1
    v_mfma_f32_16x16x32_bf16 v[104:107], v[144:147], v[48:51], v[104:107]
    ds_read_b64_tr_b16 v[132:133], v45 offset:18432
    s_waitcnt lgkmcnt(11)
    v_mfma_f32_32x32x16_bf16 v[72:87], v[148:151], v[140:143], v[72:87]
    ds_read_b64_tr_b16 v[134:135], v45 offset:19200
    ds_read_b64_tr_b16 v[136:137], v46 offset:18432
    s_waitcnt vmcnt(8)
    v_mov_b32 v2, 8
    ds_write_b32 v16, v2
    v_mfma_f32_32x32x16_bf16 v[88:103], v[152:155], v[140:143], v[88:103]
    ds_read_b64_tr_b16 v[138:139], v46 offset:19200
    s_waitcnt lgkmcnt(12)
    v_mfma_f32_32x32x16_bf16 v[56:71], v[112:115], v[108:111], v[56:71]
    ds_read_b128 v[140:143], v40 offset:4432
    ds_read_b64_tr_b16 v[144:145], v44 offset:21504
    ds_read_b64_tr_b16 v[146:147], v44 offset:22272
    v_mfma_f32_16x16x32_bf16 v[104:107], v[112:115], v[48:51], v[104:107]
    ds_read_b64_tr_b16 v[148:149], v45 offset:21504
    s_waitcnt lgkmcnt(12)
    v_mfma_f32_32x32x16_bf16 v[72:87], v[116:119], v[108:111], v[72:87]
    ds_read_b64_tr_b16 v[150:151], v45 offset:22272
    ds_read_b64_tr_b16 v[152:153], v46 offset:21504
    ds_read_b128 v[36:39], v7 offset:0
    v_mfma_f32_32x32x16_bf16 v[88:103], v[120:123], v[108:111], v[88:103]
    ds_read_b64_tr_b16 v[154:155], v46 offset:22272
    s_waitcnt lgkmcnt(13)
    v_mfma_f32_32x32x16_bf16 v[56:71], v[128:131], v[124:127], v[56:71]
    s_waitcnt lgkmcnt(1)
L_chk_13:
    v_min3_u32 v36, v36, v37, v38
    v_min_u32 v36, v36, v39
    v_cmp_gt_u32 vcc, 8, v36
    s_cbranch_vccnz L_slow_14
    v_mfma_f32_16x16x32_bf16 v[104:107], v[128:131], v[48:51], v[104:107]
    ds_read_b128 v[108:111], v40 offset:8288
    s_waitcnt lgkmcnt(9)
    v_mfma_f32_32x32x16_bf16 v[72:87], v[132:135], v[124:127], v[72:87]
    ds_read_b64_tr_b16 v[112:113], v44 offset:24576
    ds_read_b64_tr_b16 v[114:115], v44 offset:25344
    ds_read_b64_tr_b16 v[116:117], v45 offset:24576
    v_mfma_f32_32x32x16_bf16 v[88:103], v[136:139], v[124:127], v[88:103]
    ds_read_b64_tr_b16 v[118:119], v45 offset:25344
    ds_read_b64_tr_b16 v[120:121], v46 offset:24576
    ds_read_b64_tr_b16 v[122:123], v46 offset:25344
    s_waitcnt lgkmcnt(12)
    v_mfma_f32_32x32x16_bf16 v[56:71], v[144:147], v[140:143], v[56:71]
    ds_read_b128 v[124:127], v40 offset:8320
    ds_read_b64_tr_b16 v[128:129], v44 offset:27648
    ds_read_b64_tr_b16 v[130:131], v44 offset:28416
    v_mfma_f32_16x16x32_bf16 v[104:107], v[144:147], v[48:51], v[104:107]
    ds_read_b64_tr_b16 v[132:133], v45 offset:27648
    s_waitcnt lgkmcnt(11)
    v_mfma_f32_32x32x16_bf16 v[72:87], v[148:151], v[140:143], v[72:87]
    ds_read_b64_tr_b16 v[134:135], v45 offset:28416
    ds_read_b64_tr_b16 v[136:137], v46 offset:27648
    v_mfma_f32_32x32x16_bf16 v[88:103], v[152:155], v[140:143], v[88:103]
    ds_read_b64_tr_b16 v[138:139], v46 offset:28416
    s_waitcnt lgkmcnt(11)
    v_mfma_f32_32x32x16_bf16 v[56:71], v[112:115], v[108:111], v[56:71]
    ds_read_b128 v[140:143], v40 offset:8544
    ds_read_b64_tr_b16 v[144:145], v44 offset:30720
    ds_read_b64_tr_b16 v[146:147], v44 offset:31488
    v_mfma_f32_16x16x32_bf16 v[104:107], v[112:115], v[48:51], v[104:107]
    ds_read_b64_tr_b16 v[148:149], v45 offset:30720
    s_waitcnt lgkmcnt(11)
    v_mfma_f32_32x32x16_bf16 v[72:87], v[116:119], v[108:111], v[72:87]
    ds_read_b64_tr_b16 v[150:151], v45 offset:31488
    ds_read_b64_tr_b16 v[152:153], v46 offset:30720
    s_waitcnt vmcnt(1)
    v_mov_b32 v2, 9
    ds_write_b32 v16, v2
    v_mfma_f32_32x32x16_bf16 v[88:103], v[120:123], v[108:111], v[88:103]
    ds_read_b64_tr_b16 v[154:155], v46 offset:31488
    s_waitcnt lgkmcnt(12)
    v_mfma_f32_32x32x16_bf16 v[56:71], v[128:131], v[124:127], v[56:71]
    ds_read_b128 v[108:111], v40 offset:8576
    ds_read_b64_tr_b16 v[112:113], v44 offset:33792
    ds_read_b64_tr_b16 v[114:115], v44 offset:34560
    v_mfma_f32_16x16x32_bf16 v[104:107], v[128:131], v[48:51], v[104:107]
    ds_read_b64_tr_b16 v[116:117], v45 offset:33792
    s_waitcnt lgkmcnt(12)
    v_mfma_f32_32x32x16_bf16 v[72:87], v[132:135], v[124:127], v[72:87]
    ds_read_b64_tr_b16 v[118:119], v45 offset:34560
    ds_read_b64_tr_b16 v[120:121], v46 offset:33792
    ds_read_b128 v[36:39], v7 offset:0
    v_mfma_f32_32x32x16_bf16 v[88:103], v[136:139], v[124:127], v[88:103]
    ds_read_b64_tr_b16 v[122:123], v46 offset:34560
    s_waitcnt lgkmcnt(13)
    v_mfma_f32_32x32x16_bf16 v[56:71], v[144:147], v[140:143], v[56:71]
    s_waitcnt lgkmcnt(1)
L_chk_15:
    v_min3_u32 v36, v36, v37, v38
    v_min_u32 v36, v36, v39
    v_cmp_gt_u32 vcc, 9, v36
    s_cbranch_vccnz L_slow_16
    v_mfma_f32_16x16x32_bf16 v[104:107], v[144:147], v[48:51], v[104:107]
    ds_read_b128 v[124:127], v40 offset:12432
    s_waitcnt lgkmcnt(9)
    v_mfma_f32_32x32x16_bf16 v[72:87], v[148:151], v[140:143], v[72:87]
    ds_read_b64_tr_b16 v[128:129], v44 offset:36864
    ds_read_b64_tr_b16 v[130:131], v44 offset:37632
    ds_read_b64_tr_b16 v[132:133], v45 offset:36864
    v_mfma_f32_32x32x16_bf16 v[88:103], v[152:155], v[140:143], v[88:103]
    ds_read_b64_tr_b16 v[134:135], v45 offset:37632
    ds_read_b64_tr_b16 v[136:137], v46 offset:36864
    ds_read_b64_tr_b16 v[138:139], v46 offset:37632
    s_waitcnt lgkmcnt(12)
    v_mfma_f32_32x32x16_bf16 v[56:71], v[112:115], v[108:111], v[56:71]
    ds_read_b128 v[140:143], v40 offset:12464
    ds_read_b64_tr_b16 v[144:145], v44 offset:39936
    ds_read_b64_tr_b16 v[146:147], v44 offset:40704
    v_mfma_f32_16x16x32_bf16 v[104:107], v[112:115], v[48:51], v[104:107]
    ds_read_b64_tr_b16 v[148:149], v45 offset:39936
    s_waitcnt lgkmcnt(11)
    v_mfma_f32_32x32x16_bf16 v[72:87], v[116:119], v[108:111], v[72:87]
    ds_read_b64_tr_b16 v[150:151], v45 offset:40704
    ds_read_b64_tr_b16 v[152:153], v46 offset:39936
    v_mfma_f32_32x32x16_bf16 v[88:103], v[120:123], v[108:111], v[88:103]
    ds_read_b64_tr_b16 v[154:155], v46 offset:40704
    s_waitcnt lgkmcnt(11)
    v_mfma_f32_32x32x16_bf16 v[56:71], v[128:131], v[124:127], v[56:71]
    ds_read_b128 v[108:111], v40 offset:12688
    ds_read_b64_tr_b16 v[112:113], v44 offset:43008
    ds_read_b64_tr_b16 v[114:115], v44 offset:43776
    v_mfma_f32_16x16x32_bf16 v[104:107], v[128:131], v[48:51], v[104:107]
    ds_read_b64_tr_b16 v[116:117], v45 offset:43008
    s_waitcnt lgkmcnt(11)
    v_mfma_f32_32x32x16_bf16 v[72:87], v[132:135], v[124:127], v[72:87]
    ds_read_b64_tr_b16 v[118:119], v45 offset:43776
    ds_read_b64_tr_b16 v[120:121], v46 offset:43008
    v_mfma_f32_32x32x16_bf16 v[88:103], v[136:139], v[124:127], v[88:103]
    ds_read_b64_tr_b16 v[122:123], v46 offset:43776
    s_waitcnt lgkmcnt(11)
    v_mfma_f32_32x32x16_bf16 v[56:71], v[144:147], v[140:143], v[56:71]
    ds_read_b128 v[124:127], v40 offset:12720
    ds_read_b64_tr_b16 v[128:129], v44 offset:46080
    ds_read_b64_tr_b16 v[130:131], v44 offset:46848
    s_waitcnt vmcnt(0)
L_pchk_17:
    v_cmp_ne_u32 vcc, s73, v53
    v_cmp_ne_u32 s[38:39], s73, v55
    s_nop 0
    s_or_b64 vcc, vcc, s[38:39]
    s_cbranch_vccnz L_pslow_18
    v_mfma_f32_16x16x32_bf16 v[104:107], v[144:147], v[48:51], v[104:107]
    ds_read_b64_tr_b16 v[132:133], v45 offset:46080
    s_waitcnt lgkmcnt(11)
    v_mfma_f32_32x32x16_bf16 v[72:87], v[148:151], v[140:143], v[72:87]
    ds_read_b64_tr_b16 v[134:135], v45 offset:46848
    ds_read_b64_tr_b16 v[136:137], v46 offset:46080
    v_mfma_f32_32x32x16_bf16 v[88:103], v[152:155], v[140:143], v[88:103]
    ds_read_b64_tr_b16 v[138:139], v46 offset:46848
    s_waitcnt lgkmcnt(11)
    v_mfma_f32_32x32x16_bf16 v[56:71], v[112:115], v[108:111], v[56:71]
    ds_read_b128 v[172:175], v43 offset:64
    ds_read_b128 v[176:179], v43 offset:96
    v_mfma_f32_16x16x32_bf16 v[104:107], v[112:115], v[48:51], v[104:107]
    s_waitcnt lgkmcnt(9)
    v_mfma_f32_32x32x16_bf16 v[72:87], v[116:119], v[108:111], v[72:87]
    ds_read_b128 v[180:183], v43 offset:128
    ds_read_b128 v[184:187], v43 offset:160
    v_mfma_f32_32x32x16_bf16 v[88:103], v[120:123], v[108:111], v[88:103]
    ds_read_b128 v[188:191], v156 offset:64
    ds_read_b128 v[192:195], v156 offset:96
    s_waitcnt lgkmcnt(10)
    v_mfma_f32_32x32x16_bf16 v[56:71], v[128:131], v[124:127], v[56:71]
    ds_read_b128 v[196:199], v156 offset:128
    ds_read_b128 v[200:203], v156 offset:160
    v_mfma_f32_16x16x32_bf16 v[104:107], v[128:131], v[48:51], v[104:107]
    s_waitcnt lgkmcnt(8)
    v_mfma_f32_32x32x16_bf16 v[72:87], v[132:135], v[124:127], v[72:87]
    ds_read_b128 v[204:207], v157 offset:64
    ds_read_b128 v[208:211], v157 offset:96
    v_mfma_f32_32x32x16_bf16 v[88:103], v[136:139], v[124:127], v[88:103]
    ds_read_b128 v[212:215], v157 offset:128
    ds_read_b128 v[216:219], v157 offset:160
    s_mov_b32 exec_lo, 0x00030003
    s_mov_b32 exec_hi, 0x00030003
    ds_write_b128 v158, v[104:107]
    s_mov_b64 exec, -1
    v_mov_b32 v2, 10
    ds_write_b32 v16, v2
    s_mov_b32 s76, 3222493025
    v_mov_b32 v40, 3184710632
    s_lshl2_add_u32 s74, s64, s35
    s_mul_i32 s74, s74, 88064
    s_add_u32 s74, s74, 5242880
    v_add_u32 v43, 136448, v43
    v_add_u32 v156, 136448, v156
    v_add_u32 v157, 136448, v157
    s_waitcnt lgkmcnt(2)
    v_pk_fma_f32 v[56:57], v[56:57], v[52:53], v[172:173] op_sel_hi:[1,0,1]
    v_pk_fma_f32 v[58:59], v[58:59], v[52:53], v[174:175] op_sel_hi:[1,0,1]
    v_pk_fma_f32 v[60:61], v[60:61], v[52:53], v[176:177] op_sel_hi:[1,0,1]
    v_pk_fma_f32 v[62:63], v[62:63], v[52:53], v[178:179] op_sel_hi:[1,0,1]
    v_pk_fma_f32 v[64:65], v[64:65], v[52:53], v[180:181] op_sel_hi:[1,0,1]
    v_pk_fma_f32 v[66:67], v[66:67], v[52:53], v[182:183] op_sel_hi:[1,0,1]
    v_pk_fma_f32 v[68:69], v[68:69], v[52:53], v[184:185] op_sel_hi:[1,0,1]
    v_pk_fma_f32 v[70:71], v[70:71], v[52:53], v[186:187] op_sel_hi:[1,0,1]
    v_pk_fma_f32 v[72:73], v[72:73], v[52:53], v[188:189] op_sel_hi:[1,0,1]
    v_pk_fma_f32 v[74:75], v[74:75], v[52:53], v[190:191] op_sel_hi:[1,0,1]
    v_pk_fma_f32 v[76:77], v[76:77], v[52:53], v[192:193] op_sel_hi:[1,0,1]
    v_pk_fma_f32 v[78:79], v[78:79], v[52:53], v[194:195] op_sel_hi:[1,0,1]
    ds_read_b128 v[36:39], v7 offset:0
    v_pk_fma_f32 v[80:81], v[80:81], v[52:53], v[196:197] op_sel_hi:[1,0,1]
    v_pk_fma_f32 v[82:83], v[82:83], v[52:53], v[198:199] op_sel_hi:[1,0,1]
    v_pk_fma_f32 v[84:85], v[84:85], v[52:53], v[200:201] op_sel_hi:[1,0,1]
    v_pk_fma_f32 v[86:87], v[86:87], v[52:53], v[202:203] op_sel_hi:[1,0,1]
    v_pk_fma_f32 v[88:89], v[88:89], v[52:53], v[204:205] op_sel_hi:[1,0,1]
    v_pk_fma_f32 v[90:91], v[90:91], v[52:53], v[206:207] op_sel_hi:[1,0,1]
    v_pk_fma_f32 v[92:93], v[92:93], v[52:53], v[208:209] op_sel_hi:[1,0,1]
    v_pk_fma_f32 v[94:95], v[94:95], v[52:53], v[210:211] op_sel_hi:[1,0,1]
    v_pk_fma_f32 v[96:97], v[96:97], v[52:53], v[212:213] op_sel_hi:[1,0,1]
    v_pk_fma_f32 v[98:99], v[98:99], v[52:53], v[214:215] op_sel_hi:[1,0,1]
    v_pk_fma_f32 v[100:101], v[100:101], v[52:53], v[216:217] op_sel_hi:[1,0,1]
    v_pk_fma_f32 v[102:103], v[102:103], v[52:53], v[218:219] op_sel_hi:[1,0,1]
    s_waitcnt lgkmcnt(0)
L_chk_19:
    v_min3_u32 v36, v36, v37, v38
    v_min_u32 v36, v36, v39
    v_cmp_gt_u32 vcc, 10, v36
    s_cbranch_vccnz L_slow_20
    ds_read_b128 v[8:11], v43 offset:0
    ds_read_b128 v[12:15], v43 offset:32
    v_mov_b32 v6, v16
    v_mov_b32 v42, 1
    v_writelane_b32 v6, 36, 0
    s_lshl4_add_u32 s75, s64, s65
    s_lshl_b32 s75, s75, 7
    s_add_u32 s75, s75, 36864
    ds_read_b128 v[24:27], v43 offset:64
    s_waitcnt lgkmcnt(2)
    v_pk_fma_f32 v[56:57], v[8:9], v[54:55], v[56:57] op_sel_hi:[1,0,1] neg_lo:[0,1,0] neg_hi:[0,1,0]
    v_pk_fma_f32 v[58:59], v[10:11], v[54:55], v[58:59] op_sel_hi:[1,0,1] neg_lo:[0,1,0] neg_hi:[0,1,0]
    v_pk_mul_f32 v[28:29], v[56:57], v[56:57]
    v_pk_mul_f32 v[30:31], v[58:59], v[58:59]
    v_pk_fma_f32 v[28:29], v[28:29], v[40:41], s[76:77] op_sel_hi:[1,0,0]
    v_pk_fma_f32 v[30:31], v[30:31], v[40:41], s[76:77] op_sel_hi:[1,0,0]
    v_pk_mul_f32 v[28:29], v[28:29], v[56:57]
    v_pk_mul_f32 v[30:31], v[30:31], v[58:59]
    v_exp_f32 v28, v28
    v_exp_f32 v29, v29
    v_exp_f32 v30, v30
    v_exp_f32 v31, v31
    v_pk_add_f32 v[28:29], v[28:29], 1.0 op_sel_hi:[1,0]
    v_pk_add_f32 v[30:31], v[30:31], 1.0 op_sel_hi:[1,0]
    v_rcp_f32 v28, v28
    v_rcp_f32 v29, v29
    v_rcp_f32 v30, v30
    v_rcp_f32 v31, v31
    v_pk_mul_f32 v[28:29], v[28:29], v[56:57]
    v_pk_mul_f32 v[30:31], v[30:31], v[58:59]
    v_cvt_pk_bf16_f32 v108, v28, v29
    v_cvt_pk_bf16_f32 v109, v30, v31
    ds_read_b128 v[8:11], v43 offset:96
    s_waitcnt lgkmcnt(2)
    v_pk_fma_f32 v[60:61], v[12:13], v[54:55], v[60:61] op_sel_hi:[1,0,1] neg_lo:[0,1,0] neg_hi:[0,1,0]
    v_pk_fma_f32 v[62:63], v[14:15], v[54:55], v[62:63] op_sel_hi:[1,0,1] neg_lo:[0,1,0] neg_hi:[0,1,0]
    v_pk_mul_f32 v[28:29], v[60:61], v[60:61]
    v_pk_mul_f32 v[30:31], v[62:63], v[62:63]
    v_pk_fma_f32 v[28:29], v[28:29], v[40:41], s[76:77] op_sel_hi:[1,0,0]
    v_pk_fma_f32 v[30:31], v[30:31], v[40:41], s[76:77] op_sel_hi:[1,0,0]
    v_pk_mul_f32 v[28:29], v[28:29], v[60:61]
    v_pk_mul_f32 v[30:31], v[30:31], v[62:63]
    v_exp_f32 v28, v28
    v_exp_f32 v29, v29
    v_exp_f32 v30, v30
    v_exp_f32 v31, v31
    v_pk_add_f32 v[28:29], v[28:29], 1.0 op_sel_hi:[1,0]
    v_pk_add_f32 v[30:31], v[30:31], 1.0 op_sel_hi:[1,0]
    v_rcp_f32 v28, v28
    v_rcp_f32 v29, v29
    v_rcp_f32 v30, v30
    v_rcp_f32 v31, v31
    v_pk_mul_f32 v[28:29], v[28:29], v[60:61]
    v_pk_mul_f32 v[30:31], v[30:31], v[62:63]
    v_cvt_pk_bf16_f32 v110, v28, v29
    v_cvt_pk_bf16_f32 v111, v30, v31
    s_add_u32 s78, s70, s80
    s_lshl_b32 s78, s78, 11
    s_add_u32 s78, s78, s74
    s_lshl_b32 s79, s80, 2
    s_cmp_lt_u32 s79, s71
    s_cselect_b32 s78, s78, 1073741824
    buffer_store_dwordx4 v[108:111], v17, s[52:55], s78 offen offset:0 sc1
    ds_read_b128 v[12:15], v156 offset:0
    s_waitcnt lgkmcnt(2)
    v_pk_fma_f32 v[64:65], v[24:25], v[54:55], v[64:65] op_sel_hi:[1,0,1] neg_lo:[0,1,0] neg_hi:[0,1,0]
    v_pk_fma_f32 v[66:67], v[26:27], v[54:55], v[66:67] op_sel_hi:[1,0,1] neg_lo:[0,1,0] neg_hi:[0,1,0]
    v_pk_mul_f32 v[28:29], v[64:65], v[64:65]
    v_pk_mul_f32 v[30:31], v[66:67], v[66:67]
    v_pk_fma_f32 v[28:29], v[28:29], v[40:41], s[76:77] op_sel_hi:[1,0,0]
    v_pk_fma_f32 v[30:31], v[30:31], v[40:41], s[76:77] op_sel_hi:[1,0,0]
    v_pk_mul_f32 v[28:29], v[28:29], v[64:65]
    v_pk_mul_f32 v[30:31], v[30:31], v[66:67]
    v_exp_f32 v28, v28
    v_exp_f32 v29, v29
    v_exp_f32 v30, v30
    v_exp_f32 v31, v31
    v_pk_add_f32 v[28:29], v[28:29], 1.0 op_sel_hi:[1,0]
    v_pk_add_f32 v[30:31], v[30:31], 1.0 op_sel_hi:[1,0]
    v_rcp_f32 v28, v28
    v_rcp_f32 v29, v29
    v_rcp_f32 v30, v30
    v_rcp_f32 v31, v31
    v_pk_mul_f32 v[28:29], v[28:29], v[64:65]
    v_pk_mul_f32 v[30:31], v[30:31], v[66:67]
    v_cvt_pk_bf16_f32 v112, v28, v29
    v_cvt_pk_bf16_f32 v113, v30, v31
    ds_read_b128 v[24:27], v156 offset:32
    s_waitcnt lgkmcnt(2)
    v_pk_fma_f32 v[68:69], v[8:9], v[54:55], v[68:69] op_sel_hi:[1,0,1] neg_lo:[0,1,0] neg_hi:[0,1,0]
    v_pk_fma_f32 v[70:71], v[10:11], v[54:55], v[70:71] op_sel_hi:[1,0,1] neg_lo:[0,1,0] neg_hi:[0,1,0]
    v_pk_mul_f32 v[28:29], v[68:69], v[68:69]
    v_pk_mul_f32 v[30:31], v[70:71], v[70:71]
    v_pk_fma_f32 v[28:29], v[28:29], v[40:41], s[76:77] op_sel_hi:[1,0,0]
    v_pk_fma_f32 v[30:31], v[30:31], v[40:41], s[76:77] op_sel_hi:[1,0,0]
    v_pk_mul_f32 v[28:29], v[28:29], v[68:69]
    v_pk_mul_f32 v[30:31], v[30:31], v[70:71]
    v_exp_f32 v28, v28
    v_exp_f32 v29, v29
    v_exp_f32 v30, v30
    v_exp_f32 v31, v31
    v_pk_add_f32 v[28:29], v[28:29], 1.0 op_sel_hi:[1,0]
    v_pk_add_f32 v[30:31], v[30:31], 1.0 op_sel_hi:[1,0]
    v_rcp_f32 v28, v28
    v_rcp_f32 v29, v29
    v_rcp_f32 v30, v30
    v_rcp_f32 v31, v31
    v_pk_mul_f32 v[28:29], v[28:29], v[68:69]
    v_pk_mul_f32 v[30:31], v[30:31], v[70:71]
    v_cvt_pk_bf16_f32 v114, v28, v29
    v_cvt_pk_bf16_f32 v115, v30, v31
    buffer_store_dwordx4 v[112:115], v17, s[52:55], s78 offen offset:1024 sc1
    ds_read_b128 v[8:11], v156 offset:64
    s_waitcnt lgkmcnt(2)
    v_pk_fma_f32 v[72:73], v[12:13], v[54:55], v[72:73] op_sel_hi:[1,0,1] neg_lo:[0,1,0] neg_hi:[0,1,0]
    v_pk_fma_f32 v[74:75], v[14:15], v[54:55], v[74:75] op_sel_hi:[1,0,1] neg_lo:[0,1,0] neg_hi:[0,1,0]
    v_pk_mul_f32 v[28:29], v[72:73], v[72:73]
    v_pk_mul_f32 v[30:31], v[74:75], v[74:75]
    v_pk_fma_f32 v[28:29], v[28:29], v[40:41], s[76:77] op_sel_hi:[1,0,0]
    v_pk_fma_f32 v[30:31], v[30:31], v[40:41], s[76:77] op_sel_hi:[1,0,0]
    v_pk_mul_f32 v[28:29], v[28:29], v[72:73]
    v_pk_mul_f32 v[30:31], v[30:31], v[74:75]
    v_exp_f32 v28, v28
    v_exp_f32 v29, v29
    v_exp_f32 v30, v30
    v_exp_f32 v31, v31
    v_pk_add_f32 v[28:29], v[28:29], 1.0 op_sel_hi:[1,0]
    v_pk_add_f32 v[30:31], v[30:31], 1.0 op_sel_hi:[1,0]
    v_rcp_f32 v28, v28
    v_rcp_f32 v29, v29
    v_rcp_f32 v30, v30
    v_rcp_f32 v31, v31
    v_pk_mul_f32 v[28:29], v[28:29], v[72:73]
    v_pk_mul_f32 v[30:31], v[30:31], v[74:75]
    v_cvt_pk_bf16_f32 v116, v28, v29
    v_cvt_pk_bf16_f32 v117, v30, v31
    ds_read_b128 v[12:15], v156 offset:96
    s_waitcnt lgkmcnt(2)
    v_pk_fma_f32 v[76:77], v[24:25], v[54:55], v[76:77] op_sel_hi:[1,0,1] neg_lo:[0,1,0] neg_hi:[0,1,0]
    v_pk_fma_f32 v[78:79], v[26:27], v[54:55], v[78:79] op_sel_hi:[1,0,1] neg_lo:[0,1,0] neg_hi:[0,1,0]
    v_pk_mul_f32 v[28:29], v[76:77], v[76:77]
    v_pk_mul_f32 v[30:31], v[78:79], v[78:79]
    v_pk_fma_f32 v[28:29], v[28:29], v[40:41], s[76:77] op_sel_hi:[1,0,0]
    v_pk_fma_f32 v[30:31], v[30:31], v[40:41], s[76:77] op_sel_hi:[1,0,0]
    v_pk_mul_f32 v[28:29], v[28:29], v[76:77]
    v_pk_mul_f32 v[30:31], v[30:31], v[78:79]
    v_exp_f32 v28, v28
    v_exp_f32 v29, v29
    v_exp_f32 v30, v30
    v_exp_f32 v31, v31
    v_pk_add_f32 v[28:29], v[28:29], 1.0 op_sel_hi:[1,0]
    v_pk_add_f32 v[30:31], v[30:31], 1.0 op_sel_hi:[1,0]
    v_rcp_f32 v28, v28
    v_rcp_f32 v29, v29
    v_rcp_f32 v30, v30
    v_rcp_f32 v31, v31
    v_pk_mul_f32 v[28:29], v[28:29], v[76:77]
    v_pk_mul_f32 v[30:31], v[30:31], v[78:79]
    v_cvt_pk_bf16_f32 v118, v28, v29
    v_cvt_pk_bf16_f32 v119, v30, v31
    s_add_u32 s78, s70, s81
    s_lshl_b32 s78, s78, 11
    s_add_u32 s78, s78, s74
    s_lshl_b32 s79, s81, 2
    s_cmp_lt_u32 s79, s71
    s_cselect_b32 s78, s78, 1073741824
    buffer_store_dwordx4 v[116:119], v17, s[52:55], s78 offen offset:0 sc1
    ds_read_b128 v[24:27], v157 offset:0
    s_waitcnt lgkmcnt(2)
    v_pk_fma_f32 v[80:81], v[8:9], v[54:55], v[80:81] op_sel_hi:[1,0,1] neg_lo:[0,1,0] neg_hi:[0,1,0]
    v_pk_fma_f32 v[82:83], v[10:11], v[54:55], v[82:83] op_sel_hi:[1,0,1] neg_lo:[0,1,0] neg_hi:[0,1,0]
    v_pk_mul_f32 v[28:29], v[80:81], v[80:81]
    v_pk_mul_f32 v[30:31], v[82:83], v[82:83]
    v_pk_fma_f32 v[28:29], v[28:29], v[40:41], s[76:77] op_sel_hi:[1,0,0]
    v_pk_fma_f32 v[30:31], v[30:31], v[40:41], s[76:77] op_sel_hi:[1,0,0]
    v_pk_mul_f32 v[28:29], v[28:29], v[80:81]
    v_pk_mul_f32 v[30:31], v[30:31], v[82:83]
    v_exp_f32 v28, v28
    v_exp_f32 v29, v29
    v_exp_f32 v30, v30
    v_exp_f32 v31, v31
    v_pk_add_f32 v[28:29], v[28:29], 1.0 op_sel_hi:[1,0]
    v_pk_add_f32 v[30:31], v[30:31], 1.0 op_sel_hi:[1,0]
    v_rcp_f32 v28, v28
    v_rcp_f32 v29, v29
    v_rcp_f32 v30, v30
    v_rcp_f32 v31, v31
    v_pk_mul_f32 v[28:29], v[28:29], v[80:81]
    v_pk_mul_f32 v[30:31], v[30:31], v[82:83]
    v_cvt_pk_bf16_f32 v120, v28, v29
    v_cvt_pk_bf16_f32 v121, v30, v31
    ds_read_b128 v[8:11], v157 offset:32
    s_waitcnt lgkmcnt(2)
    v_pk_fma_f32 v[84:85], v[12:13], v[54:55], v[84:85] op_sel_hi:[1,0,1] neg_lo:[0,1,0] neg_hi:[0,1,0]
    v_pk_fma_f32 v[86:87], v[14:15], v[54:55], v[86:87] op_sel_hi:[1,0,1] neg_lo:[0,1,0] neg_hi:[0,1,0]
    v_pk_mul_f32 v[28:29], v[84:85], v[84:85]
    v_pk_mul_f32 v[30:31], v[86:87], v[86:87]
    v_pk_fma_f32 v[28:29], v[28:29], v[40:41], s[76:77] op_sel_hi:[1,0,0]
    v_pk_fma_f32 v[30:31], v[30:31], v[40:41], s[76:77] op_sel_hi:[1,0,0]
    v_pk_mul_f32 v[28:29], v[28:29], v[84:85]
    v_pk_mul_f32 v[30:31], v[30:31], v[86:87]
    v_exp_f32 v28, v28
    v_exp_f32 v29, v29
    v_exp_f32 v30, v30
    v_exp_f32 v31, v31
    v_pk_add_f32 v[28:29], v[28:29], 1.0 op_sel_hi:[1,0]
    v_pk_add_f32 v[30:31], v[30:31], 1.0 op_sel_hi:[1,0]
    v_rcp_f32 v28, v28
    v_rcp_f32 v29, v29
    v_rcp_f32 v30, v30
    v_rcp_f32 v31, v31
    v_pk_mul_f32 v[28:29], v[28:29], v[84:85]
    v_pk_mul_f32 v[30:31], v[30:31], v[86:87]
    v_cvt_pk_bf16_f32 v122, v28, v29
    v_cvt_pk_bf16_f32 v123, v30, v31
    buffer_store_dwordx4 v[120:123], v17, s[52:55], s78 offen offset:1024 sc1
    ds_read_b128 v[12:15], v157 offset:64
    s_waitcnt lgkmcnt(2)
    v_pk_fma_f32 v[88:89], v[24:25], v[54:55], v[88:89] op_sel_hi:[1,0,1] neg_lo:[0,1,0] neg_hi:[0,1,0]
    v_pk_fma_f32 v[90:91], v[26:27], v[54:55], v[90:91] op_sel_hi:[1,0,1] neg_lo:[0,1,0] neg_hi:[0,1,0]
    v_pk_mul_f32 v[28:29], v[88:89], v[88:89]
    v_pk_mul_f32 v[30:31], v[90:91], v[90:91]
    v_pk_fma_f32 v[28:29], v[28:29], v[40:41], s[76:77] op_sel_hi:[1,0,0]
    v_pk_fma_f32 v[30:31], v[30:31], v[40:41], s[76:77] op_sel_hi:[1,0,0]
    v_pk_mul_f32 v[28:29], v[28:29], v[88:89]
    v_pk_mul_f32 v[30:31], v[30:31], v[90:91]
    v_exp_f32 v28, v28
    v_exp_f32 v29, v29
    v_exp_f32 v30, v30
    v_exp_f32 v31, v31
    v_pk_add_f32 v[28:29], v[28:29], 1.0 op_sel_hi:[1,0]
    v_pk_add_f32 v[30:31], v[30:31], 1.0 op_sel_hi:[1,0]
    v_rcp_f32 v28, v28
    v_rcp_f32 v29, v29
    v_rcp_f32 v30, v30
    v_rcp_f32 v31, v31
    v_pk_mul_f32 v[28:29], v[28:29], v[88:89]
    v_pk_mul_f32 v[30:31], v[30:31], v[90:91]
    v_cvt_pk_bf16_f32 v108, v28, v29
    v_cvt_pk_bf16_f32 v109, v30, v31
    s_add_u32 m0, s85, 0
    s_nop 0
    buffer_load_dwordx4 v18, s[48:51], s86 offen lds
    s_add_u32 s86, s86, 16384
    s_cmp_eq_u32 s86, 704512
    s_cselect_b32 s86, 0, s86
    s_add_u32 m0, s85, 2048
    s_nop 0
    buffer_load_dwordx4 v18, s[48:51], s86 offen lds
    s_add_u32 s86, s86, 16384
    s_cmp_eq_u32 s86, 704512
    s_cselect_b32 s86, 0, s86
    s_add_u32 m0, s85, 4096
    s_nop 0
    buffer_load_dwordx4 v18, s[48:51], s86 offen lds
    s_add_u32 s86, s86, 16384
    s_cmp_eq_u32 s86, 704512
    s_cselect_b32 s86, 0, s86
    s_add_u32 m0, s85, 6144
    s_nop 0
    buffer_load_dwordx4 v18, s[48:51], s86 offen lds
    s_add_u32 s86, s86, 16384
    s_cmp_eq_u32 s86, 704512
    s_cselect_b32 s86, 0, s86
    ds_read_b128 v[24:27], v157 offset:96
    s_waitcnt lgkmcnt(2)
    v_pk_fma_f32 v[92:93], v[8:9], v[54:55], v[92:93] op_sel_hi:[1,0,1] neg_lo:[0,1,0] neg_hi:[0,1,0]
    v_pk_fma_f32 v[94:95], v[10:11], v[54:55], v[94:95] op_sel_hi:[1,0,1] neg_lo:[0,1,0] neg_hi:[0,1,0]
    v_pk_mul_f32 v[28:29], v[92:93], v[92:93]
    v_pk_mul_f32 v[30:31], v[94:95], v[94:95]
    v_pk_fma_f32 v[28:29], v[28:29], v[40:41], s[76:77] op_sel_hi:[1,0,0]
    v_pk_fma_f32 v[30:31], v[30:31], v[40:41], s[76:77] op_sel_hi:[1,0,0]
    v_pk_mul_f32 v[28:29], v[28:29], v[92:93]
    v_pk_mul_f32 v[30:31], v[30:31], v[94:95]
    v_exp_f32 v28, v28
    v_exp_f32 v29, v29
    v_exp_f32 v30, v30
    v_exp_f32 v31, v31
    v_pk_add_f32 v[28:29], v[28:29], 1.0 op_sel_hi:[1,0]
    v_pk_add_f32 v[30:31], v[30:31], 1.0 op_sel_hi:[1,0]
    v_rcp_f32 v28, v28
    v_rcp_f32 v29, v29
    v_rcp_f32 v30, v30
    v_rcp_f32 v31, v31
    v_pk_mul_f32 v[28:29], v[28:29], v[92:93]
    v_pk_mul_f32 v[30:31], v[30:31], v[94:95]
    v_cvt_pk_bf16_f32 v110, v28, v29
    v_cvt_pk_bf16_f32 v111, v30, v31
    s_add_u32 m0, s85, 8192
    s_nop 0
    buffer_load_dwordx4 v18, s[48:51], s86 offen lds
    s_add_u32 s86, s86, 16384
    s_cmp_eq_u32 s86, 704512
    s_cselect_b32 s86, 0, s86
    s_add_u32 m0, s85, 10240
    s_nop 0
    buffer_load_dwordx4 v18, s[48:51], s86 offen lds
    s_add_u32 s86, s86, 16384
    s_cmp_eq_u32 s86, 704512
    s_cselect_b32 s86, 0, s86
    s_add_u32 m0, s85, 12288
    s_nop 0
    buffer_load_dwordx4 v18, s[48:51], s86 offen lds
    s_add_u32 s86, s86, 16384
    s_cmp_eq_u32 s86, 704512
    s_cselect_b32 s86, 0, s86
    s_add_u32 m0, s85, 14336
    s_nop 0
    buffer_load_dwordx4 v18, s[48:51], s86 offen lds
    s_add_u32 s86, s86, 16384
    s_cmp_eq_u32 s86, 704512
    s_cselect_b32 s86, 0, s86
    s_add_u32 s78, s70, s82
    s_lshl_b32 s78, s78, 11
    s_add_u32 s78, s78, s74
    s_lshl_b32 s79, s82, 2
    s_cmp_lt_u32 s79, s71
    s_cselect_b32 s78, s78, 1073741824
    buffer_store_dwordx4 v[108:111], v17, s[52:55], s78 offen offset:0 sc1
    s_waitcnt lgkmcnt(1)
    v_pk_fma_f32 v[96:97], v[12:13], v[54:55], v[96:97] op_sel_hi:[1,0,1] neg_lo:[0,1,0] neg_hi:[0,1,0]
    v_pk_fma_f32 v[98:99], v[14:15], v[54:55], v[98:99] op_sel_hi:[1,0,1] neg_lo:[0,1,0] neg_hi:[0,1,0]
    v_pk_mul_f32 v[28:29], v[96:97], v[96:97]
    v_pk_mul_f32 v[30:31], v[98:99], v[98:99]
    v_pk_fma_f32 v[28:29], v[28:29], v[40:41], s[76:77] op_sel_hi:[1,0,0]
    v_pk_fma_f32 v[30:31], v[30:31], v[40:41], s[76:77] op_sel_hi:[1,0,0]
    v_pk_mul_f32 v[28:29], v[28:29], v[96:97]
    v_pk_mul_f32 v[30:31], v[30:31], v[98:99]
    v_exp_f32 v28, v28
    v_exp_f32 v29, v29
    v_exp_f32 v30, v30
    v_exp_f32 v31, v31
    v_pk_add_f32 v[28:29], v[28:29], 1.0 op_sel_hi:[1,0]
    v_pk_add_f32 v[30:31], v[30:31], 1.0 op_sel_hi:[1,0]
    v_rcp_f32 v28, v28
    v_rcp_f32 v29, v29
    v_rcp_f32 v30, v30
    v_rcp_f32 v31, v31
    v_pk_mul_f32 v[28:29], v[28:29], v[96:97]
    v_pk_mul_f32 v[30:31], v[30:31], v[98:99]
    v_cvt_pk_bf16_f32 v112, v28, v29
    v_cvt_pk_bf16_f32 v113, v30, v31
    s_add_u32 m0, s85, 16384
    s_nop 0
    buffer_load_dwordx4 v18, s[48:51], s86 offen lds
    s_add_u32 s86, s86, 16384
    s_cmp_eq_u32 s86, 704512
    s_cselect_b32 s86, 0, s86
    s_add_u32 m0, s85, 18432
    s_nop 0
    buffer_load_dwordx4 v18, s[48:51], s86 offen lds
    s_add_u32 s86, s86, 16384
    s_cmp_eq_u32 s86, 704512
    s_cselect_b32 s86, 0, s86
    s_add_u32 m0, s85, 20480
    s_nop 0
    buffer_load_dwordx4 v18, s[48:51], s86 offen lds
    s_add_u32 s86, s86, 16384
    s_cmp_eq_u32 s86, 704512
    s_cselect_b32 s86, 0, s86
    s_add_u32 m0, s85, 22528
    s_nop 0
    buffer_load_dwordx4 v18, s[48:51], s86 offen lds
    s_add_u32 s86, s86, 16384
    s_cmp_eq_u32 s86, 704512
    s_cselect_b32 s86, 0, s86
    s_waitcnt lgkmcnt(0)
    v_pk_fma_f32 v[100:101], v[24:25], v[54:55], v[100:101] op_sel_hi:[1,0,1] neg_lo:[0,1,0] neg_hi:[0,1,0]
    v_pk_fma_f32 v[102:103], v[26:27], v[54:55], v[102:103] op_sel_hi:[1,0,1] neg_lo:[0,1,0] neg_hi:[0,1,0]
    v_pk_mul_f32 v[28:29], v[100:101], v[100:101]
    v_pk_mul_f32 v[30:31], v[102:103], v[102:103]
    v_pk_fma_f32 v[28:29], v[28:29], v[40:41], s[76:77] op_sel_hi:[1,0,0]
    v_pk_fma_f32 v[30:31], v[30:31], v[40:41], s[76:77] op_sel_hi:[1,0,0]
    v_pk_mul_f32 v[28:29], v[28:29], v[100:101]
    v_pk_mul_f32 v[30:31], v[30:31], v[102:103]
    v_exp_f32 v28, v28
    v_exp_f32 v29, v29
    v_exp_f32 v30, v30
    v_exp_f32 v31, v31
    v_pk_add_f32 v[28:29], v[28:29], 1.0 op_sel_hi:[1,0]
    v_pk_add_f32 v[30:31], v[30:31], 1.0 op_sel_hi:[1,0]
    v_rcp_f32 v28, v28
    v_rcp_f32 v29, v29
    v_rcp_f32 v30, v30
    v_rcp_f32 v31, v31
    v_mov_b32 v2, 11
    ds_write_b32 v16, v2
    v_pk_mul_f32 v[28:29], v[28:29], v[100:101]
    v_pk_mul_f32 v[30:31], v[30:31], v[102:103]
    v_cvt_pk_bf16_f32 v114, v28, v29
    v_cvt_pk_bf16_f32 v115, v30, v31
    s_add_u32 m0, s85, 24576
    s_nop 0
    buffer_load_dwordx4 v18, s[48:51], s86 offen lds
    s_add_u32 s86, s86, 16384
    s_cmp_eq_u32 s86, 704512
    s_cselect_b32 s86, 0, s86
    s_add_u32 m0, s85, 26624
    s_nop 0
    buffer_load_dwordx4 v18, s[48:51], s86 offen lds
    s_add_u32 s86, s86, 16384
    s_cmp_eq_u32 s86, 704512
    s_cselect_b32 s86, 0, s86
    s_add_u32 m0, s85, 28672
    s_nop 0
    buffer_load_dwordx4 v18, s[48:51], s86 offen lds
    s_add_u32 s86, s86, 16384
    s_cmp_eq_u32 s86, 704512
    s_cselect_b32 s86, 0, s86
    buffer_store_dwordx4 v[112:115], v17, s[52:55], s78 offen offset:1024 sc1
    s_mov_b32 s78, 0xffff0000
    v_lshlrev_b32 v44, 16, v164
    v_and_b32 v45, s78, v164
    v_lshlrev_b32 v46, 16, v165
    v_and_b32 v47, s78, v165
    v_lshlrev_b32 v48, 16, v166
    v_and_b32 v49, s78, v166
    v_lshlrev_b32 v50, 16, v167
    v_and_b32 v51, s78, v167
    v_lshlrev_b32 v52, 16, v168
    v_and_b32 v53, s78, v168
    v_lshlrev_b32 v54, 16, v169
    v_and_b32 v55, s78, v169
    v_lshlrev_b32 v56, 16, v170
    v_and_b32 v57, s78, v170
    v_lshlrev_b32 v58, 16, v171
    v_and_b32 v59, s78, v171
    s_waitcnt vmcnt(0)
    ds_add_rtn_u32 v2, v6, v42
    s_waitcnt lgkmcnt(0)
    v_readfirstlane_b32 s3, v2
    s_nop 0
    s_cmp_eq_u32 s3, 3
    s_cbranch_scc1 L_pub_21
L_pubret_22:
    s_waitcnt vmcnt(1)
    v_mov_b32 v2, 12
    ds_write_b32 v16, v2
    ds_read_b128 v[36:39], v7 offset:0
    s_waitcnt lgkmcnt(0)
L_chk_23:
    v_min3_u32 v36, v36, v37, v38
    v_min_u32 v36, v36, v39
    v_cmp_gt_u32 vcc, 12, v36
    s_cbranch_vccnz L_slow_24
    ds_read_b64_tr_b16 v[8:9], v34 offset:0
    ds_read_b64_tr_b16 v[10:11], v34 offset:1024
    ds_read_b64_tr_b16 v[12:13], v35 offset:0
    ds_read_b64_tr_b16 v[14:15], v35 offset:1024
    s_add_u32 m0, s85, 30720
    s_nop 0
    buffer_load_dwordx4 v18, s[48:51], s86 offen lds
    s_add_u32 s86, s86, 16384
    s_cmp_eq_u32 s86, 704512
    s_cselect_b32 s86, 0, s86
    ds_read_b64_tr_b16 v[24:25], v34 offset:2048
    ds_read_b64_tr_b16 v[26:27], v34 offset:3072
    ds_read_b64_tr_b16 v[28:29], v35 offset:2048
    ds_read_b64_tr_b16 v[30:31], v35 offset:3072
    s_add_u32 m0, s85, 32768
    s_nop 0
    buffer_load_dwordx4 v18, s[48:51], s86 offen lds
    s_add_u32 s86, s86, 16384
    s_cmp_eq_u32 s86, 704512
    s_cselect_b32 s86, 0, s86
    ds_read_b64_tr_b16 v[76:77], v34 offset:4096
    ds_read_b64_tr_b16 v[78:79], v34 offset:5120
    ds_read_b64_tr_b16 v[80:81], v35 offset:4096
    ds_read_b64_tr_b16 v[82:83], v35 offset:5120
    s_add_u32 m0, s85, 34816
    s_nop 0
    buffer_load_dwordx4 v18, s[48:51], s86 offen lds
    s_add_u32 s86, s86, 16384
    s_cmp_eq_u32 s86, 704512
    s_cselect_b32 s86, 0, s86
    ds_read_b64_tr_b16 v[84:85], v34 offset:6144
    ds_read_b64_tr_b16 v[86:87], v34 offset:7168
    ds_read_b64_tr_b16 v[88:89], v35 offset:6144
    ds_read_b64_tr_b16 v[90:91], v35 offset:7168
    s_add_u32 m0, s85, 36864
    s_nop 0
    buffer_load_dwordx4 v18, s[48:51], s86 offen lds
    s_add_u32 s86, s86, 16384
    s_cmp_eq_u32 s86, 704512
    s_cselect_b32 s86, 0, s86
    ds_read_b64_tr_b16 v[92:93], v34 offset:8192
    ds_read_b64_tr_b16 v[94:95], v34 offset:9216
    ds_read_b64_tr_b16 v[96:97], v35 offset:8192
    ds_read_b64_tr_b16 v[98:99], v35 offset:9216
    s_add_u32 m0, s85, 38912
    s_nop 0
    buffer_load_dwordx4 v18, s[48:51], s86 offen lds
    s_add_u32 s86, s86, 16384
    s_cmp_eq_u32 s86, 704512
    s_cselect_b32 s86, 0, s86
    ds_read_b64_tr_b16 v[100:101], v34 offset:10240
    ds_read_b64_tr_b16 v[102:103], v34 offset:11264
    ds_read_b64_tr_b16 v[104:105], v35 offset:10240
    ds_read_b64_tr_b16 v[106:107], v35 offset:11264
    s_add_u32 m0, s85, 40960
    s_nop 0
    buffer_load_dwordx4 v18, s[48:51], s86 offen lds
    s_add_u32 s86, s86, 16384
    s_cmp_eq_u32 s86, 704512
    s_cselect_b32 s86, 0, s86
    ds_read_b64_tr_b16 v[108:109], v34 offset:12288
    ds_read_b64_tr_b16 v[110:111], v34 offset:13312
    ds_read_b64_tr_b16 v[112:113], v35 offset:12288
    ds_read_b64_tr_b16 v[114:115], v35 offset:13312
    s_add_u32 m0, s85, 43008
    s_nop 0
    buffer_load_dwordx4 v18, s[48:51], s86 offen lds
    s_add_u32 s86, s86, 16384
    s_cmp_eq_u32 s86, 704512
    s_cselect_b32 s86, 0, s86
    ds_read_b64_tr_b16 v[116:117], v34 offset:14336
    ds_read_b64_tr_b16 v[118:119], v34 offset:15360
    ds_read_b64_tr_b16 v[120:121], v35 offset:14336
    ds_read_b64_tr_b16 v[122:123], v35 offset:15360
    s_add_u32 m0, s85, 45056
    s_nop 0
    buffer_load_dwordx4 v18, s[48:51], s86 offen lds
    s_add_u32 s86, s86, 16384
    s_cmp_eq_u32 s86, 704512
    s_cselect_b32 s86, 0, s86
    ds_read_b64_tr_b16 v[124:125], v34 offset:16384
    ds_read_b64_tr_b16 v[126:127], v34 offset:17408
    ds_read_b64_tr_b16 v[128:129], v35 offset:16384
    ds_read_b64_tr_b16 v[130:131], v35 offset:17408
    s_add_u32 m0, s85, 47104
    s_nop 0
    buffer_load_dwordx4 v18, s[48:51], s86 offen lds
    s_add_u32 s86, s86, 16384
    s_cmp_eq_u32 s86, 704512
    s_cselect_b32 s86, 0, s86
    ds_read_b64_tr_b16 v[132:133], v34 offset:18432
    ds_read_b64_tr_b16 v[134:135], v34 offset:19456
    ds_read_b64_tr_b16 v[136:137], v35 offset:18432
    ds_read_b64_tr_b16 v[138:139], v35 offset:19456
    s_add_u32 m0, s85, 49152
    s_nop 0
    buffer_load_dwordx4 v18, s[48:51], s86 offen lds
    s_add_u32 s86, s86, 16384
    s_cmp_eq_u32 s86, 704512
    s_cselect_b32 s86, 0, s86
    ds_read_b64_tr_b16 v[140:141], v34 offset:20480
    ds_read_b64_tr_b16 v[142:143], v34 offset:21504
    ds_read_b64_tr_b16 v[144:145], v35 offset:20480
    ds_read_b64_tr_b16 v[146:147], v35 offset:21504
    s_add_u32 m0, s85, 51200
    s_nop 0
    buffer_load_dwordx4 v18, s[48:51], s86 offen lds
    s_add_u32 s86, s86, 16384
    s_cmp_eq_u32 s86, 704512
    s_cselect_b32 s86, 0, s86
    ds_read_b64_tr_b16 v[148:149], v34 offset:22528
    ds_read_b64_tr_b16 v[150:151], v34 offset:23552
    ds_read_b64_tr_b16 v[152:153], v35 offset:22528
    ds_read_b64_tr_b16 v[154:155], v35 offset:23552
    s_add_u32 m0, s85, 53248
    s_nop 0
    buffer_load_dwordx4 v18, s[48:51], s86 offen lds
    s_add_u32 s86, s86, 16384
    s_cmp_eq_u32 s86, 704512
    s_cselect_b32 s86, 0, s86
    ds_read_b64_tr_b16 v[156:157], v34 offset:24576
    ds_read_b64_tr_b16 v[158:159], v34 offset:25600
    ds_read_b64_tr_b16 v[160:161], v35 offset:24576
    ds_read_b64_tr_b16 v[162:163], v35 offset:25600
    s_add_u32 m0, s85, 55296
    s_nop 0
    buffer_load_dwordx4 v18, s[48:51], s86 offen lds
    s_add_u32 s86, s86, 16384
    s_cmp_eq_u32 s86, 704512
    s_cselect_b32 s86, 0, s86
    ds_read_b64_tr_b16 v[164:165], v34 offset:26624
    ds_read_b64_tr_b16 v[166:167], v34 offset:27648
    ds_read_b64_tr_b16 v[168:169], v35 offset:26624
    ds_read_b64_tr_b16 v[170:171], v35 offset:27648
    ds_read_b64_tr_b16 v[172:173], v34 offset:28672
    ds_read_b64_tr_b16 v[174:175], v34 offset:29696
    ds_read_b64_tr_b16 v[176:177], v35 offset:28672
    ds_read_b64_tr_b16 v[178:179], v35 offset:29696
    v_mov_b32 v2, 13
    ds_write_b32 v16, v2
    ds_read_b128 v[36:39], v7 offset:0
    s_waitcnt lgkmcnt(0)
L_chk_25:
    v_min3_u32 v36, v36, v37, v38
    v_min_u32 v36, v36, v39
    v_cmp_gt_u32 vcc, 13, v36
    s_cbranch_vccnz L_slow_26
    s_add_u32 m0, s85, 0
    s_nop 0
    buffer_load_dwordx4 v18, s[48:51], s86 offen lds
    s_add_u32 s86, s86, 16384
    s_cmp_eq_u32 s86, 704512
    s_cselect_b32 s86, 0, s86
    s_add_u32 m0, s85, 2048
    s_nop 0
    buffer_load_dwordx4 v18, s[48:51], s86 offen lds
    s_add_u32 s86, s86, 16384
    s_cmp_eq_u32 s86, 704512
    s_cselect_b32 s86, 0, s86
    s_add_u32 m0, s85, 4096
    s_nop 0
    buffer_load_dwordx4 v18, s[48:51], s86 offen lds
    s_add_u32 s86, s86, 16384
    s_cmp_eq_u32 s86, 704512
    s_cselect_b32 s86, 0, s86
    s_add_u32 m0, s85, 6144
    s_nop 0
    buffer_load_dwordx4 v18, s[48:51], s86 offen lds
    s_add_u32 s86, s86, 16384
    s_cmp_eq_u32 s86, 704512
    s_cselect_b32 s86, 0, s86
    s_add_u32 m0, s85, 8192
    s_nop 0
    buffer_load_dwordx4 v18, s[48:51], s86 offen lds
    s_add_u32 s86, s86, 16384
    s_cmp_eq_u32 s86, 704512
    s_cselect_b32 s86, 0, s86
    s_add_u32 m0, s85, 10240
    s_nop 0
    buffer_load_dwordx4 v18, s[48:51], s86 offen lds
    s_add_u32 s86, s86, 16384
    s_cmp_eq_u32 s86, 704512
    s_cselect_b32 s86, 0, s86
    s_add_u32 m0, s85, 12288
    s_nop 0
    buffer_load_dwordx4 v18, s[48:51], s86 offen lds
    s_add_u32 s86, s86, 16384
    s_cmp_eq_u32 s86, 704512
    s_cselect_b32 s86, 0, s86
    s_add_u32 m0, s85, 14336
    s_nop 0
    buffer_load_dwordx4 v18, s[48:51], s86 offen lds
    s_add_u32 s86, s86, 16384
    s_cmp_eq_u32 s86, 704512
    s_cselect_b32 s86, 0, s86
    s_add_u32 m0, s85, 16384
    s_nop 0
    buffer_load_dwordx4 v18, s[48:51], s86 offen lds
    s_add_u32 s86, s86, 16384
    s_cmp_eq_u32 s86, 704512
    s_cselect_b32 s86, 0, s86
    s_add_u32 m0, s85, 18432
    s_nop 0
    buffer_load_dwordx4 v18, s[48:51], s86 offen lds
    s_add_u32 s86, s86, 16384
    s_cmp_eq_u32 s86, 704512
    s_cselect_b32 s86, 0, s86
    s_add_u32 m0, s85, 20480
    s_nop 0
    buffer_load_dwordx4 v18, s[48:51], s86 offen lds
    s_add_u32 s86, s86, 16384
    s_cmp_eq_u32 s86, 704512
    s_cselect_b32 s86, 0, s86
    s_add_u32 m0, s85, 22528
    s_nop 0
    buffer_load_dwordx4 v18, s[48:51], s86 offen lds
    s_add_u32 s86, s86, 16384
    s_cmp_eq_u32 s86, 704512
    s_cselect_b32 s86, 0, s86
    s_add_u32 m0, s85, 24576
    s_nop 0
    buffer_load_dwordx4 v18, s[48:51], s86 offen lds
    s_add_u32 s86, s86, 16384
    s_cmp_eq_u32 s86, 704512
    s_cselect_b32 s86, 0, s86
    s_add_u32 m0, s85, 26624
    s_nop 0
    buffer_load_dwordx4 v18, s[48:51], s86 offen lds
    s_add_u32 s86, s86, 16384
    s_cmp_eq_u32 s86, 704512
    s_cselect_b32 s86, 0, s86
    s_add_u32 m0, s85, 28672
    s_nop 0
    buffer_load_dwordx4 v18, s[48:51], s86 offen lds
    s_add_u32 s86, s86, 16384
    s_cmp_eq_u32 s86, 704512
    s_cselect_b32 s86, 0, s86
    global_load_dword v4, v19, s[32:33] sc1
    s_lshl_b32 s86, s89, 10
    v_add_u32 v17, s87, v17
    s_waitcnt vmcnt(0)
L_pchk_27:
    v_cmp_ne_u32 vcc, s73, v4
    s_cbranch_vccnz L_pslow_28
    buffer_load_dwordx4 v[40:43], v17, s[52:55], s86 offen sc1
    s_add_u32 s86, s86, 1024
    s_cmp_eq_u32 s86, 44032
    s_cselect_b32 s86, 0, s86
    buffer_load_dwordx4 v[180:183], v17, s[52:55], s86 offen sc1
    s_add_u32 s86, s86, 1024
    s_cmp_eq_u32 s86, 44032
    s_cselect_b32 s86, 0, s86
    buffer_load_dwordx4 v[184:187], v17, s[52:55], s86 offen sc1
    s_add_u32 s86, s86, 1024
    s_cmp_eq_u32 s86, 44032
    s_cselect_b32 s86, 0, s86
    buffer_load_dwordx4 v[188:191], v17, s[52:55], s86 offen sc1
    s_add_u32 s86, s86, 1024
    s_cmp_eq_u32 s86, 44032
    s_cselect_b32 s86, 0, s86
    buffer_load_dwordx4 v[192:195], v17, s[52:55], s86 offen sc1
    s_add_u32 s86, s86, 1024
    s_cmp_eq_u32 s86, 44032
    s_cselect_b32 s86, 0, s86
    buffer_load_dwordx4 v[196:199], v17, s[52:55], s86 offen sc1
    s_add_u32 s86, s86, 1024
    s_cmp_eq_u32 s86, 44032
    s_cselect_b32 s86, 0, s86
    buffer_load_dwordx4 v[200:203], v17, s[52:55], s86 offen sc1
    s_add_u32 s86, s86, 1024
    s_cmp_eq_u32 s86, 44032
    s_cselect_b32 s86, 0, s86
    buffer_load_dwordx4 v[204:207], v17, s[52:55], s86 offen sc1
    s_add_u32 s86, s86, 1024
    s_cmp_eq_u32 s86, 44032
    s_cselect_b32 s86, 0, s86
    buffer_load_dwordx4 v[208:211], v17, s[52:55], s86 offen sc1
    s_add_u32 s86, s86, 1024
    s_cmp_eq_u32 s86, 44032
    s_cselect_b32 s86, 0, s86
    buffer_load_dwordx4 v[212:215], v17, s[52:55], s86 offen sc1
    s_add_u32 s86, s86, 1024
    s_cmp_eq_u32 s86, 44032
    s_cselect_b32 s86, 0, s86
    buffer_load_dwordx4 v[216:219], v17, s[52:55], s86 offen sc1
    s_add_u32 s86, s86, 1024
    s_cmp_eq_u32 s86, 44032
    s_cselect_b32 s86, 0, s86
    s_waitcnt vmcnt(10)
    v_mov_b32 v2, 14
    ds_write_b32 v16, v2
    v_mfma_f32_32x32x16_bf16 v[44:59], v[8:11], v[40:43], v[44:59]
    v_mfma_f32_32x32x16_bf16 v[60:75], v[12:15], v[40:43], 0
    buffer_load_dwordx4 v[40:43], v17, s[52:55], s86 offen sc1
    s_add_u32 s86, s86, 1024
    s_cmp_eq_u32 s86, 44032
    s_cselect_b32 s86, 0, s86
    s_waitcnt vmcnt(10)
    v_mfma_f32_32x32x16_bf16 v[44:59], v[24:27], v[180:183], v[44:59]
    v_mfma_f32_32x32x16_bf16 v[60:75], v[28:31], v[180:183], v[60:75]
    buffer_load_dwordx4 v[180:183], v17, s[52:55], s86 offen sc1
    s_add_u32 s86, s86, 1024
    s_cmp_eq_u32 s86, 44032
    s_cselect_b32 s86, 0, s86
    s_waitcnt vmcnt(10)
    v_mfma_f32_32x32x16_bf16 v[44:59], v[76:79], v[184:187], v[44:59]
    v_mfma_f32_32x32x16_bf16 v[60:75], v[80:83], v[184:187], v[60:75]
    buffer_load_dwordx4 v[184:187], v17, s[52:55], s86 offen sc1
    s_add_u32 s86, s86, 1024
    s_cmp_eq_u32 s86, 44032
    s_cselect_b32 s86, 0, s86
    s_waitcnt vmcnt(10)
    v_mfma_f32_32x32x16_bf16 v[44:59], v[84:87], v[188:191], v[44:59]
    v_mfma_f32_32x32x16_bf16 v[60:75], v[88:91], v[188:191], v[60:75]
    buffer_load_dwordx4 v[188:191], v17, s[52:55], s86 offen sc1
    s_add_u32 s86, s86, 1024
    s_cmp_eq_u32 s86, 44032
    s_cselect_b32 s86, 0, s86
    s_waitcnt vmcnt(10)
    v_mfma_f32_32x32x16_bf16 v[44:59], v[92:95], v[192:195], v[44:59]
    v_mfma_f32_32x32x16_bf16 v[60:75], v[96:99], v[192:195], v[60:75]
    buffer_load_dwordx4 v[192:195], v17, s[52:55], s86 offen sc1
    s_add_u32 s86, s86, 1024
    s_cmp_eq_u32 s86, 44032
    s_cselect_b32 s86, 0, s86
    s_waitcnt vmcnt(10)
    v_mfma_f32_32x32x16_bf16 v[44:59], v[100:103], v[196:199], v[44:59]
    v_mfma_f32_32x32x16_bf16 v[60:75], v[104:107], v[196:199], v[60:75]
    buffer_load_dwordx4 v[196:199], v17, s[52:55], s86 offen sc1
    s_add_u32 s86, s86, 1024
    s_cmp_eq_u32 s86, 44032
    s_cselect_b32 s86, 0, s86
    s_waitcnt vmcnt(10)
    v_mfma_f32_32x32x16_bf16 v[44:59], v[108:111], v[200:203], v[44:59]
    v_mfma_f32_32x32x16_bf16 v[60:75], v[112:115], v[200:203], v[60:75]
    buffer_load_dwordx4 v[200:203], v17, s[52:55], s86 offen sc1
    s_add_u32 s86, s86, 1024
    s_cmp_eq_u32 s86, 44032
    s_cselect_b32 s86, 0, s86
    s_waitcnt vmcnt(10)
    v_mfma_f32_32x32x16_bf16 v[44:59], v[116:119], v[204:207], v[44:59]
    v_mfma_f32_32x32x16_bf16 v[60:75], v[120:123], v[204:207], v[60:75]
    buffer_load_dwordx4 v[204:207], v17, s[52:55], s86 offen sc1
    s_add_u32 s86, s86, 1024
    s_cmp_eq_u32 s86, 44032
    s_cselect_b32 s86, 0, s86
    s_waitcnt vmcnt(10)
    v_mfma_f32_32x32x16_bf16 v[44:59], v[124:127], v[208:211], v[44:59]
    v_mfma_f32_32x32x16_bf16 v[60:75], v[128:131], v[208:211], v[60:75]
    buffer_load_dwordx4 v[208:211], v17, s[52:55], s86 offen sc1
    s_add_u32 s86, s86, 1024
    s_cmp_eq_u32 s86, 44032
    s_cselect_b32 s86, 0, s86
    s_waitcnt vmcnt(10)
    v_mfma_f32_32x32x16_bf16 v[44:59], v[132:135], v[212:215], v[44:59]
    v_mfma_f32_32x32x16_bf16 v[60:75], v[136:139], v[212:215], v[60:75]
    buffer_load_dwordx4 v[212:215], v17, s[52:55], s86 offen sc1
    s_add_u32 s86, s86, 1024
    s_cmp_eq_u32 s86, 44032
    s_cselect_b32 s86, 0, s86
    s_waitcnt vmcnt(10)
    v_mfma_f32_32x32x16_bf16 v[44:59], v[140:143], v[216:219], v[44:59]
    v_mfma_f32_32x32x16_bf16 v[60:75], v[144:147], v[216:219], v[60:75]
    buffer_load_dwordx4 v[216:219], v17, s[52:55], s86 offen sc1
    s_add_u32 s86, s86, 1024
    s_cmp_eq_u32 s86, 44032
    s_cselect_b32 s86, 0, s86
    ds_read_b128 v[36:39], v7 offset:0
    s_waitcnt vmcnt(10)
    v_mfma_f32_32x32x16_bf16 v[44:59], v[148:151], v[40:43], v[44:59]
    v_mfma_f32_32x32x16_bf16 v[60:75], v[152:155], v[40:43], v[60:75]
    buffer_load_dwordx4 v[40:43], v17, s[52:55], s86 offen sc1
    s_add_u32 s86, s86, 1024
    s_cmp_eq_u32 s86, 44032
    s_cselect_b32 s86, 0, s86
    s_waitcnt vmcnt(10)
    v_mfma_f32_32x32x16_bf16 v[44:59], v[156:159], v[180:183], v[44:59]
    v_mfma_f32_32x32x16_bf16 v[60:75], v[160:163], v[180:183], v[60:75]
    buffer_load_dwordx4 v[180:183], v17, s[52:55], s86 offen sc1
    s_add_u32 s86, s86, 1024
    s_cmp_eq_u32 s86, 44032
    s_cselect_b32 s86, 0, s86
    s_waitcnt lgkmcnt(0)
L_chk_29:
    v_min3_u32 v36, v36, v37, v38
    v_min_u32 v36, v36, v39
    v_cmp_gt_u32 vcc, 14, v36
    s_cbranch_vccnz L_slow_30
    s_waitcnt vmcnt(10)
    v_mfma_f32_32x32x16_bf16 v[44:59], v[164:167], v[184:187], v[44:59]
    ds_read_b64_tr_b16 v[220:221], v34 offset:30720
    ds_read_b64_tr_b16 v[222:223], v34 offset:31744
    v_mfma_f32_32x32x16_bf16 v[60:75], v[168:171], v[184:187], v[60:75]
    ds_read_b64_tr_b16 v[224:225], v35 offset:30720
    ds_read_b64_tr_b16 v[226:227], v35 offset:31744
    buffer_load_dwordx4 v[184:187], v17, s[52:55], s86 offen sc1
    s_add_u32 s86, s86, 1024
    s_cmp_eq_u32 s86, 44032
    s_cselect_b32 s86, 0, s86
    s_waitcnt vmcnt(10)
    v_mfma_f32_32x32x16_bf16 v[44:59], v[172:175], v[188:191], v[44:59]
    ds_read_b64_tr_b16 v[228:229], v34 offset:32768
    ds_read_b64_tr_b16 v[230:231], v34 offset:33792
    v_mfma_f32_32x32x16_bf16 v[60:75], v[176:179], v[188:191], v[60:75]
    ds_read_b64_tr_b16 v[232:233], v35 offset:32768
    ds_read_b64_tr_b16 v[234:235], v35 offset:33792
    buffer_load_dwordx4 v[188:191], v17, s[52:55], s86 offen sc1
    s_add_u32 s86, s86, 1024
    s_cmp_eq_u32 s86, 44032
    s_cselect_b32 s86, 0, s86
    s_waitcnt vmcnt(10) lgkmcnt(6)
    v_mfma_f32_32x32x16_bf16 v[44:59], v[220:223], v[192:195], v[44:59]
    ds_read_b64_tr_b16 v[236:237], v34 offset:34816
    ds_read_b64_tr_b16 v[238:239], v34 offset:35840
    s_waitcnt lgkmcnt(6)
    v_mfma_f32_32x32x16_bf16 v[60:75], v[224:227], v[192:195], v[60:75]
    ds_read_b64_tr_b16 v[240:241], v35 offset:34816
    ds_read_b64_tr_b16 v[242:243], v35 offset:35840
    buffer_load_dwordx4 v[192:195], v17, s[52:55], s86 offen sc1
    s_add_u32 s86, s86, 1024
    s_cmp_eq_u32 s86, 44032
    s_cselect_b32 s86, 0, s86
    s_waitcnt vmcnt(10) lgkmcnt(6)
    v_mfma_f32_32x32x16_bf16 v[44:59], v[228:231], v[196:199], v[44:59]
    ds_read_b64_tr_b16 v[220:221], v34 offset:36864
    ds_read_b64_tr_b16 v[222:223], v34 offset:37888
    s_waitcnt lgkmcnt(6)
    v_mfma_f32_32x32x16_bf16 v[60:75], v[232:235], v[196:199], v[60:75]
    ds_read_b64_tr_b16 v[224:225], v35 offset:36864
    ds_read_b64_tr_b16 v[226:227], v35 offset:37888
    buffer_load_dwordx4 v[196:199], v17, s[52:55], s86 offen sc1
    s_add_u32 s86, s86, 1024
    s_cmp_eq_u32 s86, 44032
    s_cselect_b32 s86, 0, s86
    s_waitcnt vmcnt(10) lgkmcnt(6)
    v_mfma_f32_32x32x16_bf16 v[44:59], v[236:239], v[200:203], v[44:59]
    ds_read_b64_tr_b16 v[228:229], v34 offset:38912
    ds_read_b64_tr_b16 v[230:231], v34 offset:39936
    s_waitcnt lgkmcnt(6)
    v_mfma_f32_32x32x16_bf16 v[60:75], v[240:243], v[200:203], v[60:75]
    ds_read_b64_tr_b16 v[232:233], v35 offset:38912
    ds_read_b64_tr_b16 v[234:235], v35 offset:39936
    buffer_load_dwordx4 v[200:203], v17, s[52:55], s86 offen sc1
    s_add_u32 s86, s86, 1024
    s_cmp_eq_u32 s86, 44032
    s_cselect_b32 s86, 0, s86
    s_waitcnt vmcnt(10) lgkmcnt(6)
    v_mfma_f32_32x32x16_bf16 v[44:59], v[220:223], v[204:207], v[44:59]
    ds_read_b64_tr_b16 v[236:237], v34 offset:40960
    ds_read_b64_tr_b16 v[238:239], v34 offset:41984
    s_waitcnt lgkmcnt(6)
    v_mfma_f32_32x32x16_bf16 v[60:75], v[224:227], v[204:207], v[60:75]
    ds_read_b64_tr_b16 v[240:241], v35 offset:40960
    ds_read_b64_tr_b16 v[242:243], v35 offset:41984
    buffer_load_dwordx4 v[204:207], v17, s[52:55], s86 offen sc1
    s_add_u32 s86, s86, 1024
    s_cmp_eq_u32 s86, 44032
    s_cselect_b32 s86, 0, s86
    s_waitcnt vmcnt(10) lgkmcnt(6)
    v_mfma_f32_32x32x16_bf16 v[44:59], v[228:231], v[208:211], v[44:59]
    ds_read_b64_tr_b16 v[220:221], v34 offset:43008
    ds_read_b64_tr_b16 v[222:223], v34 offset:44032
    s_waitcnt lgkmcnt(6)
    v_mfma_f32_32x32x16_bf16 v[60:75], v[232:235], v[208:211], v[60:75]
    ds_read_b64_tr_b16 v[224:225], v35 offset:43008
    ds_read_b64_tr_b16 v[226:227], v35 offset:44032
    buffer_load_dwordx4 v[208:211], v17, s[52:55], s86 offen sc1
    s_add_u32 s86, s86, 1024
    s_cmp_eq_u32 s86, 44032
    s_cselect_b32 s86, 0, s86
    s_waitcnt vmcnt(10) lgkmcnt(6)
    v_mfma_f32_32x32x16_bf16 v[44:59], v[236:239], v[212:215], v[44:59]
    ds_read_b64_tr_b16 v[228:229], v34 offset:45056
    ds_read_b64_tr_b16 v[230:231], v34 offset:46080
    s_waitcnt lgkmcnt(6)
    v_mfma_f32_32x32x16_bf16 v[60:75], v[240:243], v[212:215], v[60:75]
    ds_read_b64_tr_b16 v[232:233], v35 offset:45056
    ds_read_b64_tr_b16 v[234:235], v35 offset:46080
    buffer_load_dwordx4 v[212:215], v17, s[52:55], s86 offen sc1
    s_add_u32 s86, s86, 1024
    s_cmp_eq_u32 s86, 44032
    s_cselect_b32 s86, 0, s86
    s_waitcnt vmcnt(10) lgkmcnt(6)
    v_mfma_f32_32x32x16_bf16 v[44:59], v[220:223], v[216:219], v[44:59]
    ds_read_b64_tr_b16 v[236:237], v34 offset:47104
    ds_read_b64_tr_b16 v[238:239], v34 offset:48128
    s_waitcnt lgkmcnt(6)
    v_mfma_f32_32x32x16_bf16 v[60:75], v[224:227], v[216:219], v[60:75]
    ds_read_b64_tr_b16 v[240:241], v35 offset:47104
    ds_read_b64_tr_b16 v[242:243], v35 offset:48128
    buffer_load_dwordx4 v[216:219], v17, s[52:55], s86 offen sc1
    s_add_u32 s86, s86, 1024
    s_cmp_eq_u32 s86, 44032
    s_cselect_b32 s86, 0, s86
    s_waitcnt vmcnt(10) lgkmcnt(6)
    v_mfma_f32_32x32x16_bf16 v[44:59], v[228:231], v[40:43], v[44:59]
    ds_read_b64_tr_b16 v[220:221], v34 offset:49152
    ds_read_b64_tr_b16 v[222:223], v34 offset:50176
    s_waitcnt lgkmcnt(6)
    v_mfma_f32_32x32x16_bf16 v[60:75], v[232:235], v[40:43], v[60:75]
    ds_read_b64_tr_b16 v[224:225], v35 offset:49152
    ds_read_b64_tr_b16 v[226:227], v35 offset:50176
    buffer_load_dwordx4 v[40:43], v17, s[52:55], s86 offen sc1
    s_add_u32 s86, s86, 1024
    s_cmp_eq_u32 s86, 44032
    s_cselect_b32 s86, 0, s86
    s_waitcnt vmcnt(10) lgkmcnt(6)
    v_mfma_f32_32x32x16_bf16 v[44:59], v[236:239], v[180:183], v[44:59]
    ds_read_b64_tr_b16 v[228:229], v34 offset:51200
    ds_read_b64_tr_b16 v[230:231], v34 offset:52224
    s_waitcnt lgkmcnt(6)
    v_mfma_f32_32x32x16_bf16 v[60:75], v[240:243], v[180:183], v[60:75]
    ds_read_b64_tr_b16 v[232:233], v35 offset:51200
    ds_read_b64_tr_b16 v[234:235], v35 offset:52224
    buffer_load_dwordx4 v[180:183], v17, s[52:55], s86 offen sc1
    s_add_u32 s86, s86, 1024
    s_cmp_eq_u32 s86, 44032
    s_cselect_b32 s86, 0, s86
    s_waitcnt vmcnt(10) lgkmcnt(6)
    v_mfma_f32_32x32x16_bf16 v[44:59], v[220:223], v[184:187], v[44:59]
    ds_read_b64_tr_b16 v[236:237], v34 offset:53248
    ds_read_b64_tr_b16 v[238:239], v34 offset:54272
    s_waitcnt lgkmcnt(6)
    v_mfma_f32_32x32x16_bf16 v[60:75], v[224:227], v[184:187], v[60:75]
    ds_read_b64_tr_b16 v[240:241], v35 offset:53248
    ds_read_b64_tr_b16 v[242:243], v35 offset:54272
    buffer_load_dwordx4 v[184:187], v17, s[52:55], s86 offen sc1
    s_add_u32 s86, s86, 1024
    s_cmp_eq_u32 s86, 44032
    s_cselect_b32 s86, 0, s86
    s_waitcnt vmcnt(10) lgkmcnt(6)
    v_mfma_f32_32x32x16_bf16 v[44:59], v[228:231], v[188:191], v[44:59]
    ds_read_b64_tr_b16 v[220:221], v34 offset:55296
    ds_read_b64_tr_b16 v[222:223], v34 offset:56320
    s_waitcnt lgkmcnt(6)
    v_mfma_f32_32x32x16_bf16 v[60:75], v[232:235], v[188:191], v[60:75]
    ds_read_b64_tr_b16 v[224:225], v35 offset:55296
    ds_read_b64_tr_b16 v[226:227], v35 offset:56320
    buffer_load_dwordx4 v[188:191], v17, s[52:55], s86 offen sc1
    s_add_u32 s86, s86, 1024
    s_cmp_eq_u32 s86, 44032
    s_cselect_b32 s86, 0, s86
    s_waitcnt vmcnt(10) lgkmcnt(6)
    v_mfma_f32_32x32x16_bf16 v[44:59], v[236:239], v[192:195], v[44:59]
    ds_read_b64_tr_b16 v[228:229], v34 offset:0
    ds_read_b64_tr_b16 v[230:231], v34 offset:1024
    s_waitcnt lgkmcnt(6)
    v_mfma_f32_32x32x16_bf16 v[60:75], v[240:243], v[192:195], v[60:75]
    ds_read_b64_tr_b16 v[232:233], v35 offset:0
    ds_read_b64_tr_b16 v[234:235], v35 offset:1024
    buffer_load_dwordx4 v[192:195], v17, s[52:55], s86 offen sc1
    s_add_u32 s86, s86, 1024
    s_cmp_eq_u32 s86, 44032
    s_cselect_b32 s86, 0, s86
    s_waitcnt vmcnt(10) lgkmcnt(6)
    v_mfma_f32_32x32x16_bf16 v[44:59], v[220:223], v[196:199], v[44:59]
    ds_read_b64_tr_b16 v[236:237], v34 offset:2048
    ds_read_b64_tr_b16 v[238:239], v34 offset:3072
    s_waitcnt lgkmcnt(6)
    v_mfma_f32_32x32x16_bf16 v[60:75], v[224:227], v[196:199], v[60:75]
    ds_read_b64_tr_b16 v[240:241], v35 offset:2048
    ds_read_b64_tr_b16 v[242:243], v35 offset:3072
    buffer_load_dwordx4 v[196:199], v17, s[52:55], s86 offen sc1
    s_add_u32 s86, s86, 1024
    s_cmp_eq_u32 s86, 44032
    s_cselect_b32 s86, 0, s86
    s_waitcnt vmcnt(10) lgkmcnt(6)
    v_mfma_f32_32x32x16_bf16 v[44:59], v[228:231], v[200:203], v[44:59]
    ds_read_b64_tr_b16 v[220:221], v34 offset:4096
    ds_read_b64_tr_b16 v[222:223], v34 offset:5120
    s_waitcnt lgkmcnt(6)
    v_mfma_f32_32x32x16_bf16 v[60:75], v[232:235], v[200:203], v[60:75]
    ds_read_b64_tr_b16 v[224:225], v35 offset:4096
    ds_read_b64_tr_b16 v[226:227], v35 offset:5120
    buffer_load_dwordx4 v[200:203], v17, s[52:55], s86 offen sc1
    s_add_u32 s86, s86, 1024
    s_cmp_eq_u32 s86, 44032
    s_cselect_b32 s86, 0, s86
    s_waitcnt vmcnt(10) lgkmcnt(6)
    v_mfma_f32_32x32x16_bf16 v[44:59], v[236:239], v[204:207], v[44:59]
    ds_read_b64_tr_b16 v[228:229], v34 offset:6144
    ds_read_b64_tr_b16 v[230:231], v34 offset:7168
    s_waitcnt lgkmcnt(6)
    v_mfma_f32_32x32x16_bf16 v[60:75], v[240:243], v[204:207], v[60:75]
    ds_read_b64_tr_b16 v[232:233], v35 offset:6144
    ds_read_b64_tr_b16 v[234:235], v35 offset:7168
    buffer_load_dwordx4 v[204:207], v17, s[52:55], s86 offen sc1
    s_add_u32 s86, s86, 1024
    s_cmp_eq_u32 s86, 44032
    s_cselect_b32 s86, 0, s86
    s_waitcnt vmcnt(10) lgkmcnt(6)
    v_mfma_f32_32x32x16_bf16 v[44:59], v[220:223], v[208:211], v[44:59]
    ds_read_b64_tr_b16 v[236:237], v34 offset:8192
    ds_read_b64_tr_b16 v[238:239], v34 offset:9216
    s_waitcnt lgkmcnt(6)
    v_mfma_f32_32x32x16_bf16 v[60:75], v[224:227], v[208:211], v[60:75]
    ds_read_b64_tr_b16 v[240:241], v35 offset:8192
    ds_read_b64_tr_b16 v[242:243], v35 offset:9216
    buffer_load_dwordx4 v[208:211], v17, s[52:55], s86 offen sc1
    s_add_u32 s86, s86, 1024
    s_cmp_eq_u32 s86, 44032
    s_cselect_b32 s86, 0, s86
    v_mov_b32 v2, 15
    ds_write_b32 v16, v2
    s_waitcnt vmcnt(10) lgkmcnt(7)
    v_mfma_f32_32x32x16_bf16 v[44:59], v[228:231], v[212:215], v[44:59]
    ds_read_b64_tr_b16 v[220:221], v34 offset:10240
    ds_read_b64_tr_b16 v[222:223], v34 offset:11264
    s_waitcnt lgkmcnt(7)
    v_mfma_f32_32x32x16_bf16 v[60:75], v[232:235], v[212:215], v[60:75]
    ds_read_b64_tr_b16 v[224:225], v35 offset:10240
    ds_read_b64_tr_b16 v[226:227], v35 offset:11264
    buffer_load_dwordx4 v[212:215], v17, s[52:55], s86 offen sc1
    s_waitcnt vmcnt(10) lgkmcnt(7)
    v_mfma_f32_32x32x16_bf16 v[44:59], v[236:239], v[216:219], v[44:59]
    ds_read_b64_tr_b16 v[228:229], v34 offset:12288
    ds_read_b64_tr_b16 v[230:231], v34 offset:13312
    s_waitcnt lgkmcnt(7)
    v_mfma_f32_32x32x16_bf16 v[60:75], v[240:243], v[216:219], v[60:75]
    ds_read_b64_tr_b16 v[232:233], v35 offset:12288
    ds_read_b64_tr_b16 v[234:235], v35 offset:13312
    s_waitcnt vmcnt(9) lgkmcnt(6)
    v_mfma_f32_32x32x16_bf16 v[44:59], v[220:223], v[40:43], v[44:59]
    ds_read_b64_tr_b16 v[236:237], v34 offset:14336
    ds_read_b64_tr_b16 v[238:239], v34 offset:15360
    s_waitcnt lgkmcnt(6)
    v_mfma_f32_32x32x16_bf16 v[60:75], v[224:227], v[40:43], v[60:75]
    ds_read_b64_tr_b16 v[240:241], v35 offset:14336
    ds_read_b64_tr_b16 v[242:243], v35 offset:15360
    s_waitcnt vmcnt(8) lgkmcnt(6)
    v_mfma_f32_32x32x16_bf16 v[44:59], v[228:231], v[180:183], v[44:59]
    ds_read_b64_tr_b16 v[220:221], v34 offset:16384
    ds_read_b64_tr_b16 v[222:223], v34 offset:17408
    s_waitcnt lgkmcnt(6)
    v_mfma_f32_32x32x16_bf16 v[60:75], v[232:235], v[180:183], v[60:75]
    ds_read_b64_tr_b16 v[224:225], v35 offset:16384
    ds_read_b64_tr_b16 v[226:227], v35 offset:17408
    s_waitcnt vmcnt(7) lgkmcnt(6)
    v_mfma_f32_32x32x16_bf16 v[44:59], v[236:239], v[184:187], v[44:59]
    ds_read_b64_tr_b16 v[228:229], v34 offset:18432
    ds_read_b64_tr_b16 v[230:231], v34 offset:19456
    s_waitcnt lgkmcnt(6)
    v_mfma_f32_32x32x16_bf16 v[60:75], v[240:243], v[184:187], v[60:75]
    ds_read_b64_tr_b16 v[232:233], v35 offset:18432
    ds_read_b64_tr_b16 v[234:235], v35 offset:19456
    s_waitcnt vmcnt(6) lgkmcnt(6)
    v_mfma_f32_32x32x16_bf16 v[44:59], v[220:223], v[188:191], v[44:59]
    ds_read_b64_tr_b16 v[236:237], v34 offset:20480
    ds_read_b64_tr_b16 v[238:239], v34 offset:21504
    s_waitcnt lgkmcnt(6)
    v_mfma_f32_32x32x16_bf16 v[60:75], v[224:227], v[188:191], v[60:75]
    ds_read_b64_tr_b16 v[240:241], v35 offset:20480
    ds_read_b64_tr_b16 v[242:243], v35 offset:21504
    ds_read_b128 v[36:39], v7 offset:0
    s_waitcnt vmcnt(5) lgkmcnt(7)
    v_mfma_f32_32x32x16_bf16 v[44:59], v[228:231], v[192:195], v[44:59]
    ds_read_b64_tr_b16 v[220:221], v34 offset:22528
    ds_read_b64_tr_b16 v[222:223], v34 offset:23552
    s_waitcnt lgkmcnt(7)
    v_mfma_f32_32x32x16_bf16 v[60:75], v[232:235], v[192:195], v[60:75]
    ds_read_b64_tr_b16 v[224:225], v35 offset:22528
    ds_read_b64_tr_b16 v[226:227], v35 offset:23552
    s_waitcnt vmcnt(4) lgkmcnt(7)
    v_mfma_f32_32x32x16_bf16 v[44:59], v[236:239], v[196:199], v[44:59]
    ds_read_b64_tr_b16 v[228:229], v34 offset:24576
    ds_read_b64_tr_b16 v[230:231], v34 offset:25600
    s_waitcnt lgkmcnt(7)
    v_mfma_f32_32x32x16_bf16 v[60:75], v[240:243], v[196:199], v[60:75]
    ds_read_b64_tr_b16 v[232:233], v35 offset:24576
    ds_read_b64_tr_b16 v[234:235], v35 offset:25600
    s_waitcnt lgkmcnt(8)
L_chk_31:
    v_min3_u32 v36, v36, v37, v38
    v_min_u32 v36, v36, v39
    v_cmp_gt_u32 vcc, 15, v36
    s_cbranch_vccnz L_slow_32
    s_waitcnt vmcnt(3) lgkmcnt(6)
    v_mfma_f32_32x32x16_bf16 v[44:59], v[220:223], v[200:203], v[44:59]
    ds_read_b64_tr_b16 v[236:237], v34 offset:26624
    ds_read_b64_tr_b16 v[238:239], v34 offset:27648
    s_waitcnt lgkmcnt(6)
    v_mfma_f32_32x32x16_bf16 v[60:75], v[224:227], v[200:203], v[60:75]
    ds_read_b64_tr_b16 v[240:241], v35 offset:26624
    ds_read_b64_tr_b16 v[242:243], v35 offset:27648
    ds_read_b64_tr_b16 v[224:225], v35 offset:28672
    ds_read_b64_tr_b16 v[226:227], v35 offset:29696
    ds_read_b64_tr_b16 v[220:221], v34 offset:28672
    ds_read_b64_tr_b16 v[222:223], v34 offset:29696
    s_waitcnt vmcnt(2) lgkmcnt(8)
    v_mfma_f32_32x32x16_bf16 v[60:75], v[232:235], v[204:207], v[60:75]
    s_waitcnt vmcnt(1) lgkmcnt(4)
    v_mfma_f32_32x32x16_bf16 v[60:75], v[240:243], v[208:211], v[60:75]
    s_waitcnt vmcnt(0) lgkmcnt(2)
    v_mfma_f32_32x32x16_bf16 v[60:75], v[224:227], v[212:215], v[60:75]
    s_waitcnt lgkmcnt(10)
    v_mfma_f32_32x32x16_bf16 v[44:59], v[228:231], v[204:207], v[44:59]
    s_waitcnt lgkmcnt(6)
    v_mfma_f32_32x32x16_bf16 v[44:59], v[236:239], v[208:211], v[44:59]
    s_waitcnt lgkmcnt(0)
    v_mfma_f32_32x32x16_bf16 v[44:59], v[220:223], v[212:215], v[44:59]
    s_nop 5
    ds_write_b128 v32, v[60:63] offset:0
    ds_write_b128 v32, v[64:67] offset:1024
    ds_write_b128 v32, v[68:71] offset:2048
    ds_write_b128 v32, v[72:75] offset:3072
    v_mov_b32 v2, 16
    ds_write_b32 v16, v2
    ds_read_b128 v[36:39], v7 offset:16
    s_mov_b32 s76, 3216550459
    s_mov_b32 s79, 16384
    v_mov_b32 v40, v20
    v_xor_b32 v41, 16, v20
    v_xor_b32 v42, 32, v20
    v_xor_b32 v43, 48, v20
    ds_read_b128 v[140:143], v7 offset:0
    s_waitcnt lgkmcnt(0)
L_chk_33:
    v_min3_u32 v140, v140, v141, v142
    v_min_u32 v140, v140, v143
    v_cmp_gt_u32 vcc, 16, v140
    s_cbranch_vccnz L_slow_34
    ds_read_b128 v[76:79], v33 offset:0
    ds_read_b128 v[80:83], v33 offset:1024
    ds_read_b128 v[84:87], v33 offset:2048
    ds_read_b128 v[88:91], v33 offset:3072
    s_waitcnt lgkmcnt(3)
    v_pk_add_f32 v[44:45], v[44:45], v[76:77]
    v_pk_add_f32 v[46:47], v[46:47], v[78:79]
    v_pk_mul_f32 v[124:125], v[44:45], s[76:77] op_sel_hi:[1,0]
    v_pk_mul_f32 v[126:127], v[46:47], s[76:77] op_sel_hi:[1,0]
    v_exp_f32 v124, v124
    v_exp_f32 v125, v125
    v_exp_f32 v126, v126
    v_exp_f32 v127, v127
    v_pk_add_f32 v[124:125], v[124:125], 1.0 op_sel_hi:[1,0]
    v_pk_add_f32 v[126:127], v[126:127], 1.0 op_sel_hi:[1,0]
    v_rcp_f32 v124, v124
    v_rcp_f32 v125, v125
    v_rcp_f32 v126, v126
    v_rcp_f32 v127, v127
    v_pk_mul_f32 v[44:45], v[44:45], v[124:125]
    v_pk_mul_f32 v[46:47], v[46:47], v[126:127]
    s_waitcnt lgkmcnt(2)
    v_pk_add_f32 v[48:49], v[48:49], v[80:81]
    v_pk_add_f32 v[50:51], v[50:51], v[82:83]
    v_pk_mul_f32 v[128:129], v[48:49], s[76:77] op_sel_hi:[1,0]
    v_pk_mul_f32 v[130:131], v[50:51], s[76:77] op_sel_hi:[1,0]
    v_exp_f32 v128, v128
    v_exp_f32 v129, v129
    v_exp_f32 v130, v130
    v_exp_f32 v131, v131
    v_pk_add_f32 v[128:129], v[128:129], 1.0 op_sel_hi:[1,0]
    v_pk_add_f32 v[130:131], v[130:131], 1.0 op_sel_hi:[1,0]
    v_rcp_f32 v128, v128
    v_rcp_f32 v129, v129
    v_rcp_f32 v130, v130
    v_rcp_f32 v131, v131
    v_pk_mul_f32 v[48:49], v[48:49], v[128:129]
    v_pk_mul_f32 v[50:51], v[50:51], v[130:131]
    s_waitcnt lgkmcnt(1)
    v_pk_add_f32 v[52:53], v[52:53], v[84:85]
    v_pk_add_f32 v[54:55], v[54:55], v[86:87]
    v_pk_mul_f32 v[132:133], v[52:53], s[76:77] op_sel_hi:[1,0]
    v_pk_mul_f32 v[134:135], v[54:55], s[76:77] op_sel_hi:[1,0]
    v_exp_f32 v132, v132
    v_exp_f32 v133, v133
    v_exp_f32 v134, v134
    v_exp_f32 v135, v135
    v_pk_add_f32 v[132:133], v[132:133], 1.0 op_sel_hi:[1,0]
    v_pk_add_f32 v[134:135], v[134:135], 1.0 op_sel_hi:[1,0]
    v_rcp_f32 v132, v132
    v_rcp_f32 v133, v133
    v_rcp_f32 v134, v134
    v_rcp_f32 v135, v135
    v_pk_mul_f32 v[52:53], v[52:53], v[132:133]
    v_pk_mul_f32 v[54:55], v[54:55], v[134:135]
    s_waitcnt lgkmcnt(0)
    v_pk_add_f32 v[56:57], v[56:57], v[88:89]
    v_pk_add_f32 v[58:59], v[58:59], v[90:91]
    v_pk_mul_f32 v[136:137], v[56:57], s[76:77] op_sel_hi:[1,0]
    v_pk_mul_f32 v[138:139], v[58:59], s[76:77] op_sel_hi:[1,0]
    v_exp_f32 v136, v136
    v_exp_f32 v137, v137
    v_exp_f32 v138, v138
    v_exp_f32 v139, v139
    v_pk_add_f32 v[136:137], v[136:137], 1.0 op_sel_hi:[1,0]
    v_pk_add_f32 v[138:139], v[138:139], 1.0 op_sel_hi:[1,0]
    v_rcp_f32 v136, v136
    v_rcp_f32 v137, v137
    v_rcp_f32 v138, v138
    v_rcp_f32 v139, v139
    v_pk_mul_f32 v[56:57], v[56:57], v[136:137]
    v_pk_mul_f32 v[58:59], v[58:59], v[138:139]
    s_waitcnt lgkmcnt(5)
L_chk_35:
    v_min3_u32 v36, v36, v37, v38
    v_min_u32 v36, v36, v39
    v_cmp_gt_u32 vcc, 10, v36
    s_cbranch_vccnz L_slow_36
    ds_read_b64_tr_b16 v[8:9], v21 offset:704
    ds_read_b64 v[24:25], v40
    ds_read_b64_tr_b16 v[10:11], v21 offset:2240
    ds_read_b64 v[26:27], v41
    ds_read_b64_tr_b16 v[12:13], v21 offset:3776
    ds_read_b64 v[28:29], v42
    ds_read_b64_tr_b16 v[14:15], v21 offset:5312
    ds_read_b64 v[30:31], v43
    s_waitcnt lgkmcnt(0)
    v_lshlrev_b32 v92, 16, v8
    v_and_b32 v93, s78, v8
    v_lshlrev_b32 v94, 16, v9
    v_and_b32 v95, s78, v9
    v_lshlrev_b32 v108, 16, v24
    v_and_b32 v109, s78, v24
    v_lshlrev_b32 v110, 16, v25
    v_and_b32 v111, s78, v25
    v_pk_fma_f32 v[44:45], v[44:45], v[92:93], v[108:109]
    v_pk_fma_f32 v[46:47], v[46:47], v[94:95], v[110:111]
    v_cvt_pk_bf16_f32 v24, v44, v45
    v_cvt_pk_bf16_f32 v25, v46, v47
    ds_write_b64 v40, v[24:25]
    v_lshlrev_b32 v96, 16, v10
    v_and_b32 v97, s78, v10
    v_lshlrev_b32 v98, 16, v11
    v_and_b32 v99, s78, v11
    v_lshlrev_b32 v112, 16, v26
    v_and_b32 v113, s78, v26
    v_lshlrev_b32 v114, 16, v27
    v_and_b32 v115, s78, v27
    v_pk_fma_f32 v[48:49], v[48:49], v[96:97], v[112:113]
    v_pk_fma_f32 v[50:51], v[50:51], v[98:99], v[114:115]
    v_cvt_pk_bf16_f32 v26, v48, v49
    v_cvt_pk_bf16_f32 v27, v50, v51
    ds_write_b64 v41, v[26:27]
    v_lshlrev_b32 v100, 16, v12
    v_and_b32 v101, s78, v12
    v_lshlrev_b32 v102, 16, v13
    v_and_b32 v103, s78, v13
    v_lshlrev_b32 v116, 16, v28
    v_and_b32 v117, s78, v28
    v_lshlrev_b32 v118, 16, v29
    v_and_b32 v119, s78, v29
    v_pk_fma_f32 v[52:53], v[52:53], v[100:101], v[116:117]
    v_pk_fma_f32 v[54:55], v[54:55], v[102:103], v[118:119]
    v_cvt_pk_bf16_f32 v28, v52, v53
    v_cvt_pk_bf16_f32 v29, v54, v55
    ds_write_b64 v42, v[28:29]
    v_lshlrev_b32 v104, 16, v14
    v_and_b32 v105, s78, v14
    v_lshlrev_b32 v106, 16, v15
    v_and_b32 v107, s78, v15
    v_lshlrev_b32 v120, 16, v30
    v_and_b32 v121, s78, v30
    v_lshlrev_b32 v122, 16, v31
    v_and_b32 v123, s78, v31
    v_pk_fma_f32 v[56:57], v[56:57], v[104:105], v[120:121]
    v_pk_fma_f32 v[58:59], v[58:59], v[106:107], v[122:123]
    v_cvt_pk_bf16_f32 v30, v56, v57
    v_cvt_pk_bf16_f32 v31, v58, v59
    ds_write_b64 v43, v[30:31]
    ds_read_b128 v[76:79], v22
    ds_read_b128 v[80:83], v22 offset:2048
    s_waitcnt lgkmcnt(1)
    buffer_store_dwordx4 v[76:79], v23, s[56:59], 0 offen
    s_waitcnt lgkmcnt(0)
    buffer_store_dwordx4 v[80:83], v23, s[56:59], s79 offen
L_end:
    s_endpgm
L_S:
    v_mov_b32 v3, 0
    v_mov_b32 v12, 0
    v_mov_b32 v13, 0
    v_mov_b32 v14, 0
    v_mov_b32 v15, 0
    s_mov_b32 s88, 0
    ds_write_b128 v21, v[12:15]
    s_mov_b32 s52, s32
    s_mov_b32 s53, s33
    s_mov_b32 s54, 10878976
    s_mov_b32 s55, 0x20000
    s_mov_b32 s40, s4
    s_mov_b32 s41, s5
    s_mov_b32 s42, 2097152
    s_mov_b32 s43, 0x20000
    s_lshl_b32 s74, s35, 2
    s_add_u32 s74, s74, 16
    v_lshlrev_b32 v20, 2, v1
    v_add_u32 v20, 448, v20
    v_mov_b32 v22, v20
    v_mov_b32 v23, 1
    v_writelane_b32 v20, s74, 0
    v_writelane_b32 v22, 32, 0
    s_mov_b32 s74, 0xffff0000
    v_bfe_u32 v28, v1, 2, 2
    v_mul_u32_u24 v28, 1088, v28
    v_lshrrev_b32 v29, 4, v1
    v_lshl_add_u32 v28, v29, 5, v28
    v_and_b32 v29, 3, v1
    v_lshl_add_u32 v28, v29, 3, v28
    s_lshl_b32 s78, s35, 8
    v_add_u32 v34, s78, v28
    s_lshl2_add_u32 s78, s66, s35
    s_lshl_b32 s78, s78, 11
    s_add_u32 s78, s78, 1048576
    v_lshl_add_u32 v35, v1, 4, s78
    s_waitcnt lgkmcnt(0)
    s_barrier
    s_mov_b32 s78, 1069066811
    s_mov_b32 s79, 849703008
    s_mov_b32 s80, 1060205080
    s_bitcmp1_b32 s35, 1
    s_cselect_b32 s81, 0, 16
    s_lshl_b32 s86, s86, s81
    s_and_b32 s86, s86, 0xffff0000
    s_lshl_b32 s87, s87, s81
    s_and_b32 s87, s87, 0xffff0000
    v_mov_b32 v28, s86
    s_waitcnt vmcnt(0)
    v_lshlrev_b32 v4, 16, v4
    v_lshlrev_b32 v5, 16, v5
    v_lshlrev_b32 v6, 16, v6
    v_lshlrev_b32 v7, 16, v7
    v_mul_f32 v29, s78, v28
    v_fma_f32 v30, v28, s78, -v29
    v_exp_f32 v40, v29
    v_fma_f32 v30, v28, s79, v30
    v_mul_f32 v30, s80, v30
    v_fma_f32 v40, v40, v30, v40
    v_mul_f32 v32, s78, v4
    v_fma_f32 v33, v4, s78, -v32
    v_exp_f32 v31, v32
    v_fma_f32 v33, v4, s79, v33
    v_mul_f32 v33, s80, v33
    v_fma_f32 v31, v31, v33, v31
    v_and_b32 v28, 0x7fffffff, v6
    v_and_b32 v29, 0x7fffffff, v7
    v_max_u32 v28, v28, v29
    v_cvt_pk_bf16_f32 v40, v40, v40
    v_lshlrev_b32 v40, 16, v40
    v_cvt_pk_bf16_f32 v31, v31, v31
    v_lshlrev_b32 v31, 16, v31
    v_max_u32_dpp v28, v28, v28 quad_perm:[1,0,3,2] row_mask:0xf bank_mask:0xf
    s_nop 1
    v_max_u32_dpp v28, v28, v28 quad_perm:[2,3,0,1] row_mask:0xf bank_mask:0xf
    s_nop 1
    v_max_u32_dpp v28, v28, v28 row_half_mirror row_mask:0xf bank_mask:0xf
    s_nop 1
    v_max_u32_dpp v28, v28, v28 row_mirror row_mask:0xf bank_mask:0xf
    v_mov_b32 v29, v28
    s_nop 1
    v_permlane16_swap_b32 v28, v29
    v_max_u32 v28, v28, v29
    v_mov_b32 v29, v28
    s_nop 1
    v_permlane32_swap_b32 v28, v29
    v_max_u32 v28, v28, v29
    v_mul_f32 v31, v31, v40
    v_mul_f32 v32, v5, v40
    v_mul_f32 v36, 3216550459, v31
    v_mul_f32 v32, 1042479491, v32
    v_rndne_f32 v33, v32
    v_sub_f32 v37, v32, v33
    v_and_b32 v28, 0x7f800000, v28
    v_max_u32 v28, 0x00800000, v28
    v_min_u32 v28, 0x7e800000, v28
    v_sub_u32 v29, 0x7f000000, v28
    v_mul_f32 v38, v6, v29
    v_mul_f32 v39, v7, v29
    v_add_f32 v40, v40, v40
    v_mul_f32 v42, v40, v28
    s_lshl_b32 s81, s35, 10
    v_lshl_add_u32 v28, v1, 4, s81
    v_lshrrev_b32 v29, 4, v1
    v_lshl_add_u32 v29, v29, 6, s81
    ds_write_b128 v28, v[36:39] offset:15072
    ds_read_b128 v[44:47], v29 offset:15072
    ds_read_b128 v[48:51], v29 offset:15088
    ds_read_b128 v[52:55], v29 offset:15104
    ds_read_b128 v[56:59], v29 offset:15120
    ds_read_b128 v[60:63], v29 offset:15328
    ds_read_b128 v[64:67], v29 offset:15344
    ds_read_b128 v[68:71], v29 offset:15360
    ds_read_b128 v[72:75], v29 offset:15376
    ds_read_b128 v[76:79], v29 offset:15584
    ds_read_b128 v[80:83], v29 offset:15600
    ds_read_b128 v[84:87], v29 offset:15616
    ds_read_b128 v[88:91], v29 offset:15632
    ds_read_b128 v[92:95], v29 offset:15840
    ds_read_b128 v[96:99], v29 offset:15856
    ds_read_b128 v[100:103], v29 offset:15872
    ds_read_b128 v[104:107], v29 offset:15888
    s_lshl_b32 s81, s35, 10
    s_add_u32 s81, s81, 4096
    v_lshl_add_u32 v5, v1, 4, s81
    s_lshl_b32 s82, s66, 4
    s_add_u32 s82, s82, 4096
    v_mov_b32 v160, v8
    v_mov_b32 v162, v9
    v_mov_b32 v164, v10
    v_mov_b32 v166, v11
    s_waitcnt lgkmcnt(14)
    v_pk_mul_f32 v[142:143], v[44:45], v[166:167] op_sel_hi:[1,0]
    v_pk_mul_f32 v[136:137], v[44:45], v[160:161] op_sel_hi:[1,0]
    v_pk_mul_f32 v[138:139], v[44:45], v[162:163] op_sel_hi:[1,0]
    v_pk_mul_f32 v[140:141], v[44:45], v[164:165] op_sel_hi:[1,0]
    v_fract_f32 v139, v139
    v_fract_f32 v141, v141
    v_exp_f32 v158, v142
    v_cos_f32 v150, v143
    v_sin_f32 v151, v143
    v_exp_f32 v152, v136
    v_cos_f32 v144, v137
    v_sin_f32 v145, v137
    v_exp_f32 v154, v138
    v_cos_f32 v146, v139
    v_sin_f32 v147, v139
    v_exp_f32 v156, v140
    v_cos_f32 v148, v141
    v_sin_f32 v149, v141
    v_pk_mul_f32 v[150:151], v[150:151], v[158:159] op_sel_hi:[1,0]
    v_pk_mul_f32 v[144:145], v[144:145], v[152:153] op_sel_hi:[1,0]
    v_pk_mul_f32 v[146:147], v[146:147], v[154:155] op_sel_hi:[1,0]
    v_pk_mul_f32 v[148:149], v[148:149], v[156:157] op_sel_hi:[1,0]
    v_pk_mul_f32 v[136:137], v[150:151], v[46:47] op_sel_hi:[1,0] neg_hi:[1,0]
    v_cvt_pk_f16_f32 v108, v144, v145
    v_fma_f32 v136, -v151, v47, v136
    v_fma_f32 v137, -v150, v47, v137
    v_cvt_pk_f16_f32 v112, v146, v147
    v_cvt_pk_f16_f32 v116, v148, v149
    v_cvt_pk_f16_f32 v120, v136, v137
    s_waitcnt lgkmcnt(14)
    v_pk_mul_f32 v[142:143], v[48:49], v[166:167] op_sel_hi:[1,0]
    v_pk_mul_f32 v[136:137], v[48:49], v[160:161] op_sel_hi:[1,0]
    v_pk_mul_f32 v[138:139], v[48:49], v[162:163] op_sel_hi:[1,0]
    v_pk_mul_f32 v[140:141], v[48:49], v[164:165] op_sel_hi:[1,0]
    v_fract_f32 v139, v139
    v_fract_f32 v141, v141
    v_exp_f32 v158, v142
    v_cos_f32 v150, v143
    v_sin_f32 v151, v143
    v_exp_f32 v152, v136
    v_cos_f32 v144, v137
    v_sin_f32 v145, v137
    v_exp_f32 v154, v138
    v_cos_f32 v146, v139
    v_sin_f32 v147, v139
    v_exp_f32 v156, v140
    v_cos_f32 v148, v141
    v_sin_f32 v149, v141
    v_pk_mul_f32 v[150:151], v[150:151], v[158:159] op_sel_hi:[1,0]
    v_pk_mul_f32 v[144:145], v[144:145], v[152:153] op_sel_hi:[1,0]
    v_pk_mul_f32 v[146:147], v[146:147], v[154:155] op_sel_hi:[1,0]
    v_pk_mul_f32 v[148:149], v[148:149], v[156:157] op_sel_hi:[1,0]
    v_pk_mul_f32 v[136:137], v[150:151], v[50:51] op_sel_hi:[1,0] neg_hi:[1,0]
    v_cvt_pk_f16_f32 v109, v144, v145
    v_fma_f32 v136, -v151, v51, v136
    v_fma_f32 v137, -v150, v51, v137
    v_cvt_pk_f16_f32 v113, v146, v147
    v_cvt_pk_f16_f32 v117, v148, v149
    v_cvt_pk_f16_f32 v121, v136, v137
    s_waitcnt lgkmcnt(13)
    v_pk_mul_f32 v[142:143], v[52:53], v[166:167] op_sel_hi:[1,0]
    v_pk_mul_f32 v[136:137], v[52:53], v[160:161] op_sel_hi:[1,0]
    v_pk_mul_f32 v[138:139], v[52:53], v[162:163] op_sel_hi:[1,0]
    v_pk_mul_f32 v[140:141], v[52:53], v[164:165] op_sel_hi:[1,0]
    v_fract_f32 v139, v139
    v_fract_f32 v141, v141
    v_exp_f32 v158, v142
    v_cos_f32 v150, v143
    v_sin_f32 v151, v143
    v_exp_f32 v152, v136
    v_cos_f32 v144, v137
    v_sin_f32 v145, v137
    v_exp_f32 v154, v138
    v_cos_f32 v146, v139
    v_sin_f32 v147, v139
    v_exp_f32 v156, v140
    v_cos_f32 v148, v141
    v_sin_f32 v149, v141
    v_pk_mul_f32 v[150:151], v[150:151], v[158:159] op_sel_hi:[1,0]
    v_pk_mul_f32 v[144:145], v[144:145], v[152:153] op_sel_hi:[1,0]
    v_pk_mul_f32 v[146:147], v[146:147], v[154:155] op_sel_hi:[1,0]
    v_pk_mul_f32 v[148:149], v[148:149], v[156:157] op_sel_hi:[1,0]
    v_pk_mul_f32 v[136:137], v[150:151], v[54:55] op_sel_hi:[1,0] neg_hi:[1,0]
    v_cvt_pk_f16_f32 v110, v144, v145
    v_fma_f32 v136, -v151, v55, v136
    v_fma_f32 v137, -v150, v55, v137
    v_cvt_pk_f16_f32 v114, v146, v147
    v_cvt_pk_f16_f32 v118, v148, v149
    v_cvt_pk_f16_f32 v122, v136, v137
    ds_read_b128 v[24:27], v3 offset:0
    s_waitcnt lgkmcnt(13)
    v_pk_mul_f32 v[142:143], v[56:57], v[166:167] op_sel_hi:[1,0]
    v_pk_mul_f32 v[136:137], v[56:57], v[160:161] op_sel_hi:[1,0]
    v_pk_mul_f32 v[138:139], v[56:57], v[162:163] op_sel_hi:[1,0]
    v_pk_mul_f32 v[140:141], v[56:57], v[164:165] op_sel_hi:[1,0]
    v_fract_f32 v139, v139
    v_fract_f32 v141, v141
    v_exp_f32 v158, v142
    v_cos_f32 v150, v143
    v_sin_f32 v151, v143
    v_exp_f32 v152, v136
    v_cos_f32 v144, v137
    v_sin_f32 v145, v137
    v_exp_f32 v154, v138
    v_cos_f32 v146, v139
    v_sin_f32 v147, v139
    v_exp_f32 v156, v140
    v_cos_f32 v148, v141
    v_sin_f32 v149, v141
    v_pk_mul_f32 v[150:151], v[150:151], v[158:159] op_sel_hi:[1,0]
    v_pk_mul_f32 v[144:145], v[144:145], v[152:153] op_sel_hi:[1,0]
    v_pk_mul_f32 v[146:147], v[146:147], v[154:155] op_sel_hi:[1,0]
    v_pk_mul_f32 v[148:149], v[148:149], v[156:157] op_sel_hi:[1,0]
    v_pk_mul_f32 v[136:137], v[150:151], v[58:59] op_sel_hi:[1,0] neg_hi:[1,0]
    v_cvt_pk_f16_f32 v111, v144, v145
    v_fma_f32 v136, -v151, v59, v136
    v_fma_f32 v137, -v150, v59, v137
    v_cvt_pk_f16_f32 v115, v146, v147
    v_cvt_pk_f16_f32 v119, v148, v149
    v_cvt_pk_f16_f32 v123, v136, v137
    s_waitcnt lgkmcnt(0)
L_chk_37:
    v_min3_u32 v24, v24, v25, v26
    v_min_u32 v24, v24, v27
    v_cmp_gt_u32 vcc, 1, v24
    s_cbranch_vccnz L_slow_38
    ds_read_b64_tr_b16 v[168:169], v34 offset:5856
    ds_read_b64_tr_b16 v[170:171], v34 offset:10208
    ds_read_b64_tr_b16 v[172:173], v34 offset:5984
    ds_read_b64_tr_b16 v[174:175], v34 offset:10336
    ds_read_b32 v2, v3 offset:44
    v_mov_b32 v29, 2
    ds_write_b32 v20, v29
    v_mfma_f32_16x16x32_f16 v[124:127], v[108:111], v[120:123], 0
    v_mfma_f32_16x16x32_f16 v[128:131], v[112:115], v[120:123], 0
    v_mfma_f32_16x16x32_f16 v[132:135], v[116:119], v[120:123], 0
    s_waitcnt lgkmcnt(14)
    v_pk_mul_f32 v[142:143], v[60:61], v[166:167] op_sel_hi:[1,0]
    v_pk_mul_f32 v[136:137], v[60:61], v[160:161] op_sel_hi:[1,0]
    v_pk_mul_f32 v[138:139], v[60:61], v[162:163] op_sel_hi:[1,0]
    v_pk_mul_f32 v[140:141], v[60:61], v[164:165] op_sel_hi:[1,0]
    v_fract_f32 v139, v139
    v_fract_f32 v141, v141
    v_exp_f32 v158, v142
    v_cos_f32 v150, v143
    v_sin_f32 v151, v143
    v_exp_f32 v152, v136
    v_cos_f32 v144, v137
    v_sin_f32 v145, v137
    v_exp_f32 v154, v138
    v_cos_f32 v146, v139
    v_sin_f32 v147, v139
    v_exp_f32 v156, v140
    v_cos_f32 v148, v141
    v_sin_f32 v149, v141
    v_pk_mul_f32 v[150:151], v[150:151], v[158:159] op_sel_hi:[1,0]
    v_pk_mul_f32 v[144:145], v[144:145], v[152:153] op_sel_hi:[1,0]
    v_pk_mul_f32 v[146:147], v[146:147], v[154:155] op_sel_hi:[1,0]
    v_pk_mul_f32 v[148:149], v[148:149], v[156:157] op_sel_hi:[1,0]
    v_pk_mul_f32 v[136:137], v[150:151], v[62:63] op_sel_hi:[1,0] neg_hi:[1,0]
    v_cvt_pk_f16_f32 v108, v144, v145
    v_fma_f32 v136, -v151, v63, v136
    v_fma_f32 v137, -v150, v63, v137
    v_cvt_pk_f16_f32 v112, v146, v147
    v_cvt_pk_f16_f32 v116, v148, v149
    v_cvt_pk_f16_f32 v120, v136, v137
    s_waitcnt lgkmcnt(1)
    buffer_store_dwordx4 v[168:171], v35, s[52:55], 0 offen sc1
    buffer_store_dwordx4 v[172:175], v35, s[52:55], 0 offen offset:1024 sc1
    v_readfirstlane_b32 s73, v2
    s_waitcnt lgkmcnt(14)
    v_pk_mul_f32 v[142:143], v[64:65], v[166:167] op_sel_hi:[1,0]
    v_pk_mul_f32 v[136:137], v[64:65], v[160:161] op_sel_hi:[1,0]
    v_pk_mul_f32 v[138:139], v[64:65], v[162:163] op_sel_hi:[1,0]
    v_pk_mul_f32 v[140:141], v[64:65], v[164:165] op_sel_hi:[1,0]
    v_fract_f32 v139, v139
    v_fract_f32 v141, v141
    v_exp_f32 v158, v142
    v_cos_f32 v150, v143
    v_sin_f32 v151, v143
    v_exp_f32 v152, v136
    v_cos_f32 v144, v137
    v_sin_f32 v145, v137
    v_exp_f32 v154, v138
    v_cos_f32 v146, v139
    v_sin_f32 v147, v139
    v_exp_f32 v156, v140
    v_cos_f32 v148, v141
    v_sin_f32 v149, v141
    v_pk_mul_f32 v[150:151], v[150:151], v[158:159] op_sel_hi:[1,0]
    v_pk_mul_f32 v[144:145], v[144:145], v[152:153] op_sel_hi:[1,0]
    v_pk_mul_f32 v[146:147], v[146:147], v[154:155] op_sel_hi:[1,0]
    v_pk_mul_f32 v[148:149], v[148:149], v[156:157] op_sel_hi:[1,0]
    v_pk_mul_f32 v[136:137], v[150:151], v[66:67] op_sel_hi:[1,0] neg_hi:[1,0]
    v_cvt_pk_f16_f32 v109, v144, v145
    v_fma_f32 v136, -v151, v67, v136
    v_fma_f32 v137, -v150, v67, v137
    v_cvt_pk_f16_f32 v113, v146, v147
    v_cvt_pk_f16_f32 v117, v148, v149
    v_cvt_pk_f16_f32 v121, v136, v137
    s_waitcnt lgkmcnt(14)
    v_pk_mul_f32 v[142:143], v[68:69], v[166:167] op_sel_hi:[1,0]
    v_pk_mul_f32 v[136:137], v[68:69], v[160:161] op_sel_hi:[1,0]
    v_pk_mul_f32 v[138:139], v[68:69], v[162:163] op_sel_hi:[1,0]
    v_pk_mul_f32 v[140:141], v[68:69], v[164:165] op_sel_hi:[1,0]
    v_fract_f32 v139, v139
    v_fract_f32 v141, v141
    v_exp_f32 v158, v142
    v_cos_f32 v150, v143
    v_sin_f32 v151, v143
    v_exp_f32 v152, v136
    v_cos_f32 v144, v137
    v_sin_f32 v145, v137
    v_exp_f32 v154, v138
    v_cos_f32 v146, v139
    v_sin_f32 v147, v139
    v_exp_f32 v156, v140
    v_cos_f32 v148, v141
    v_sin_f32 v149, v141
    v_pk_mul_f32 v[150:151], v[150:151], v[158:159] op_sel_hi:[1,0]
    v_pk_mul_f32 v[144:145], v[144:145], v[152:153] op_sel_hi:[1,0]
    v_pk_mul_f32 v[146:147], v[146:147], v[154:155] op_sel_hi:[1,0]
    v_pk_mul_f32 v[148:149], v[148:149], v[156:157] op_sel_hi:[1,0]
    v_pk_mul_f32 v[136:137], v[150:151], v[70:71] op_sel_hi:[1,0] neg_hi:[1,0]
    v_cvt_pk_f16_f32 v110, v144, v145
    v_fma_f32 v136, -v151, v71, v136
    v_fma_f32 v137, -v150, v71, v137
    v_cvt_pk_f16_f32 v114, v146, v147
    v_cvt_pk_f16_f32 v118, v148, v149
    v_cvt_pk_f16_f32 v122, v136, v137
    s_waitcnt lgkmcnt(14)
    v_pk_mul_f32 v[142:143], v[72:73], v[166:167] op_sel_hi:[1,0]
    v_pk_mul_f32 v[136:137], v[72:73], v[160:161] op_sel_hi:[1,0]
    v_pk_mul_f32 v[138:139], v[72:73], v[162:163] op_sel_hi:[1,0]
    v_pk_mul_f32 v[140:141], v[72:73], v[164:165] op_sel_hi:[1,0]
    v_fract_f32 v139, v139
    v_fract_f32 v141, v141
    v_exp_f32 v158, v142
    v_cos_f32 v150, v143
    v_sin_f32 v151, v143
    v_exp_f32 v152, v136
    v_cos_f32 v144, v137
    v_sin_f32 v145, v137
    v_exp_f32 v154, v138
    v_cos_f32 v146, v139
    v_sin_f32 v147, v139
    v_exp_f32 v156, v140
    v_cos_f32 v148, v141
    v_sin_f32 v149, v141
    v_pk_mul_f32 v[150:151], v[150:151], v[158:159] op_sel_hi:[1,0]
    v_pk_mul_f32 v[144:145], v[144:145], v[152:153] op_sel_hi:[1,0]
    v_pk_mul_f32 v[146:147], v[146:147], v[154:155] op_sel_hi:[1,0]
    v_pk_mul_f32 v[148:149], v[148:149], v[156:157] op_sel_hi:[1,0]
    v_pk_mul_f32 v[136:137], v[150:151], v[74:75] op_sel_hi:[1,0] neg_hi:[1,0]
    v_cvt_pk_f16_f32 v111, v144, v145
    v_fma_f32 v136, -v151, v75, v136
    v_fma_f32 v137, -v150, v75, v137
    v_cvt_pk_f16_f32 v115, v146, v147
    v_cvt_pk_f16_f32 v119, v148, v149
    v_cvt_pk_f16_f32 v123, v136, v137
    s_nop 1
    v_mfma_f32_16x16x32_f16 v[124:127], v[108:111], v[120:123], v[124:127]
    v_mfma_f32_16x16x32_f16 v[128:131], v[112:115], v[120:123], v[128:131]
    v_mfma_f32_16x16x32_f16 v[132:135], v[116:119], v[120:123], v[132:135]
    s_waitcnt lgkmcnt(14)
    v_mul_f32 v142, v76, v11
    v_mul_f32 v143, v77, v11
    v_mul_f32 v136, v76, v8
    v_mul_f32 v137, v77, v8
    v_mul_f32 v138, v76, v9
    v_mul_f32 v139, v77, v9
    v_mul_f32 v140, v76, v10
    v_mul_f32 v141, v77, v10
    v_fract_f32 v139, v139
    v_fract_f32 v141, v141
    v_exp_f32 v158, v142
    v_cos_f32 v150, v143
    v_sin_f32 v151, v143
    v_exp_f32 v152, v136
    v_cos_f32 v144, v137
    v_sin_f32 v145, v137
    v_exp_f32 v154, v138
    v_cos_f32 v146, v139
    v_sin_f32 v147, v139
    v_exp_f32 v156, v140
    v_cos_f32 v148, v141
    v_sin_f32 v149, v141
    v_mul_f32 v150, v150, v158
    v_mul_f32 v151, v151, v158
    v_mul_f32 v144, v144, v152
    v_mul_f32 v145, v145, v152
    v_mul_f32 v146, v146, v154
    v_mul_f32 v147, v147, v154
    v_mul_f32 v148, v148, v156
    v_mul_f32 v149, v149, v156
    v_mul_f32 v136, v150, v78
    v_mul_f32_e64 v137, -v151, v78
    v_cvt_pk_f16_f32 v108, v144, v145
    v_fma_f32 v136, -v151, v79, v136
    v_fma_f32 v137, -v150, v79, v137
    v_cvt_pk_f16_f32 v112, v146, v147
    v_cvt_pk_f16_f32 v116, v148, v149
    v_cvt_pk_f16_f32 v120, v136, v137
    s_waitcnt lgkmcnt(13)
    v_mul_f32 v142, v80, v11
    v_mul_f32 v143, v81, v11
    v_mul_f32 v136, v80, v8
    v_mul_f32 v137, v81, v8
    v_mul_f32 v138, v80, v9
    v_mul_f32 v139, v81, v9
    v_mul_f32 v140, v80, v10
    v_mul_f32 v141, v81, v10
    v_fract_f32 v139, v139
    v_fract_f32 v141, v141
    v_exp_f32 v158, v142
    v_cos_f32 v150, v143
    v_sin_f32 v151, v143
    v_exp_f32 v152, v136
    v_cos_f32 v144, v137
    v_sin_f32 v145, v137
    v_exp_f32 v154, v138
    v_cos_f32 v146, v139
    v_sin_f32 v147, v139
    v_exp_f32 v156, v140
    v_cos_f32 v148, v141
    v_sin_f32 v149, v141
    v_mul_f32 v150, v150, v158
    v_mul_f32 v151, v151, v158
    v_mul_f32 v144, v144, v152
    v_mul_f32 v145, v145, v152
    v_mul_f32 v146, v146, v154
    v_mul_f32 v147, v147, v154
    v_mul_f32 v148, v148, v156
    v_mul_f32 v149, v149, v156
    v_mul_f32 v136, v150, v82
    v_mul_f32_e64 v137, -v151, v82
    v_cvt_pk_f16_f32 v109, v144, v145
    v_fma_f32 v136, -v151, v83, v136
    v_fma_f32 v137, -v150, v83, v137
    v_cvt_pk_f16_f32 v113, v146, v147
    v_cvt_pk_f16_f32 v117, v148, v149
    v_cvt_pk_f16_f32 v121, v136, v137
    s_waitcnt vmcnt(0)
    ds_add_rtn_u32 v30, v22, v23
    s_waitcnt lgkmcnt(0)
    v_readfirstlane_b32 s3, v30
    s_nop 0
    s_cmp_eq_u32 s3, 3
    s_cbranch_scc1 L_pub_39
L_pubret_40:
    global_load_dwordx4 v[12:15], v21, s[38:39] offset:1024
    global_load_dwordx4 v[16:19], v21, s[38:39] offset:2048
    s_waitcnt lgkmcnt(13)
    v_mul_f32 v142, v84, v11
    v_mul_f32 v143, v85, v11
    v_mul_f32 v136, v84, v8
    v_mul_f32 v137, v85, v8
    v_mul_f32 v138, v84, v9
    v_mul_f32 v139, v85, v9
    v_mul_f32 v140, v84, v10
    v_mul_f32 v141, v85, v10
    v_fract_f32 v139, v139
    v_fract_f32 v141, v141
    v_exp_f32 v158, v142
    v_cos_f32 v150, v143
    v_sin_f32 v151, v143
    v_exp_f32 v152, v136
    v_cos_f32 v144, v137
    v_sin_f32 v145, v137
    v_exp_f32 v154, v138
    v_cos_f32 v146, v139
    v_sin_f32 v147, v139
    v_exp_f32 v156, v140
    v_cos_f32 v148, v141
    v_sin_f32 v149, v141
    v_mul_f32 v150, v150, v158
    v_mul_f32 v151, v151, v158
    v_mul_f32 v144, v144, v152
    v_mul_f32 v145, v145, v152
    v_mul_f32 v146, v146, v154
    v_mul_f32 v147, v147, v154
    v_mul_f32 v148, v148, v156
    v_mul_f32 v149, v149, v156
    v_mul_f32 v136, v150, v86
    v_mul_f32_e64 v137, -v151, v86
    v_cvt_pk_f16_f32 v110, v144, v145
    v_fma_f32 v136, -v151, v87, v136
    v_fma_f32 v137, -v150, v87, v137
    v_cvt_pk_f16_f32 v114, v146, v147
    v_cvt_pk_f16_f32 v118, v148, v149
    v_cvt_pk_f16_f32 v122, v136, v137
    s_waitcnt lgkmcnt(12)
    v_mul_f32 v142, v88, v11
    v_mul_f32 v143, v89, v11
    v_mul_f32 v136, v88, v8
    v_mul_f32 v137, v89, v8
    v_mul_f32 v138, v88, v9
    v_mul_f32 v139, v89, v9
    v_mul_f32 v140, v88, v10
    v_mul_f32 v141, v89, v10
    v_fract_f32 v139, v139
    v_fract_f32 v141, v141
    v_exp_f32 v158, v142
    v_cos_f32 v150, v143
    v_sin_f32 v151, v143
    v_exp_f32 v152, v136
    v_cos_f32 v144, v137
    v_sin_f32 v145, v137
    v_exp_f32 v154, v138
    v_cos_f32 v146, v139
    v_sin_f32 v147, v139
    v_exp_f32 v156, v140
    v_cos_f32 v148, v141
    v_sin_f32 v149, v141
    v_mul_f32 v150, v150, v158
    v_mul_f32 v151, v151, v158
    v_mul_f32 v144, v144, v152
    v_mul_f32 v145, v145, v152
    v_mul_f32 v146, v146, v154
    v_mul_f32 v147, v147, v154
    v_mul_f32 v148, v148, v156
    v_mul_f32 v149, v149, v156
    v_mul_f32 v136, v150, v90
    v_mul_f32_e64 v137, -v151, v90
    v_cvt_pk_f16_f32 v111, v144, v145
    v_fma_f32 v136, -v151, v91, v136
    v_fma_f32 v137, -v150, v91, v137
    v_cvt_pk_f16_f32 v115, v146, v147
    v_cvt_pk_f16_f32 v119, v148, v149
    v_cvt_pk_f16_f32 v123, v136, v137
    s_nop 1
    v_mfma_f32_16x16x32_f16 v[124:127], v[108:111], v[120:123], v[124:127]
    v_mfma_f32_16x16x32_f16 v[128:131], v[112:115], v[120:123], v[128:131]
    v_mfma_f32_16x16x32_f16 v[132:135], v[116:119], v[120:123], v[132:135]
    s_waitcnt lgkmcnt(11)
    v_mul_f32 v142, v92, v11
    v_mul_f32 v143, v93, v11
    v_mul_f32 v136, v92, v8
    v_mul_f32 v137, v93, v8
    v_mul_f32 v138, v92, v9
    v_mul_f32 v139, v93, v9
    v_mul_f32 v140, v92, v10
    v_mul_f32 v141, v93, v10
    v_fract_f32 v139, v139
    v_fract_f32 v141, v141
    v_exp_f32 v158, v142
    v_cos_f32 v150, v143
    v_sin_f32 v151, v143
    v_exp_f32 v152, v136
    v_cos_f32 v144, v137
    v_sin_f32 v145, v137
    v_exp_f32 v154, v138
    v_cos_f32 v146, v139
    v_sin_f32 v147, v139
    v_exp_f32 v156, v140
    v_cos_f32 v148, v141
    v_sin_f32 v149, v141
    v_mul_f32 v150, v150, v158
    v_mul_f32 v151, v151, v158
    v_mul_f32 v144, v144, v152
    v_mul_f32 v145, v145, v152
    v_mul_f32 v146, v146, v154
    v_mul_f32 v147, v147, v154
    v_mul_f32 v148, v148, v156
    v_mul_f32 v149, v149, v156
    v_mul_f32 v136, v150, v94
    v_mul_f32_e64 v137, -v151, v94
    v_cvt_pk_f16_f32 v108, v144, v145
    v_fma_f32 v136, -v151, v95, v136
    v_fma_f32 v137, -v150, v95, v137
    v_cvt_pk_f16_f32 v112, v146, v147
    v_cvt_pk_f16_f32 v116, v148, v149
    v_cvt_pk_f16_f32 v120, v136, v137
    s_waitcnt lgkmcnt(10)
    v_mul_f32 v142, v96, v11
    v_mul_f32 v143, v97, v11
    v_mul_f32 v136, v96, v8
    v_mul_f32 v137, v97, v8
    v_mul_f32 v138, v96, v9
    v_mul_f32 v139, v97, v9
    v_mul_f32 v140, v96, v10
    v_mul_f32 v141, v97, v10
    v_fract_f32 v139, v139
    v_fract_f32 v141, v141
    v_exp_f32 v158, v142
    v_cos_f32 v150, v143
    v_sin_f32 v151, v143
    v_exp_f32 v152, v136
    v_cos_f32 v144, v137
    v_sin_f32 v145, v137
    v_exp_f32 v154, v138
    v_cos_f32 v146, v139
    v_sin_f32 v147, v139
    v_exp_f32 v156, v140
    v_cos_f32 v148, v141
    v_sin_f32 v149, v141
    v_mul_f32 v150, v150, v158
    v_mul_f32 v151, v151, v158
    v_mul_f32 v144, v144, v152
    v_mul_f32 v145, v145, v152
    v_mul_f32 v146, v146, v154
    v_mul_f32 v147, v147, v154
    v_mul_f32 v148, v148, v156
    v_mul_f32 v149, v149, v156
    v_mul_f32 v136, v150, v98
    v_mul_f32_e64 v137, -v151, v98
    v_cvt_pk_f16_f32 v109, v144, v145
    v_fma_f32 v136, -v151, v99, v136
    v_fma_f32 v137, -v150, v99, v137
    v_cvt_pk_f16_f32 v113, v146, v147
    v_cvt_pk_f16_f32 v117, v148, v149
    v_cvt_pk_f16_f32 v121, v136, v137
    s_waitcnt lgkmcnt(9)
    v_mul_f32 v142, v100, v11
    v_mul_f32 v143, v101, v11
    v_mul_f32 v136, v100, v8
    v_mul_f32 v137, v101, v8
    v_mul_f32 v138, v100, v9
    v_mul_f32 v139, v101, v9
    v_mul_f32 v140, v100, v10
    v_mul_f32 v141, v101, v10
    v_fract_f32 v139, v139
    v_fract_f32 v141, v141
    v_exp_f32 v158, v142
    v_cos_f32 v150, v143
    v_sin_f32 v151, v143
    v_exp_f32 v152, v136
    v_cos_f32 v144, v137
    v_sin_f32 v145, v137
    v_exp_f32 v154, v138
    v_cos_f32 v146, v139
    v_sin_f32 v147, v139
    v_exp_f32 v156, v140
    v_cos_f32 v148, v141
    v_sin_f32 v149, v141
    v_mul_f32 v150, v150, v158
    v_mul_f32 v151, v151, v158
    v_mul_f32 v144, v144, v152
    v_mul_f32 v145, v145, v152
    v_mul_f32 v146, v146, v154
    v_mul_f32 v147, v147, v154
    v_mul_f32 v148, v148, v156
    v_mul_f32 v149, v149, v156
    v_mul_f32 v136, v150, v102
    v_mul_f32_e64 v137, -v151, v102
    v_cvt_pk_f16_f32 v110, v144, v145
    v_fma_f32 v136, -v151, v103, v136
    v_fma_f32 v137, -v150, v103, v137
    v_cvt_pk_f16_f32 v114, v146, v147
    v_cvt_pk_f16_f32 v118, v148, v149
    v_cvt_pk_f16_f32 v122, v136, v137
    s_waitcnt lgkmcnt(8)
    v_mul_f32 v142, v104, v11
    v_mul_f32 v143, v105, v11
    v_mul_f32 v136, v104, v8
    v_mul_f32 v137, v105, v8
    v_mul_f32 v138, v104, v9
    v_mul_f32 v139, v105, v9
    v_mul_f32 v140, v104, v10
    v_mul_f32 v141, v105, v10
    v_fract_f32 v139, v139
    v_fract_f32 v141, v141
    v_exp_f32 v158, v142
    v_cos_f32 v150, v143
    v_sin_f32 v151, v143
    v_exp_f32 v152, v136
    v_cos_f32 v144, v137
    v_sin_f32 v145, v137
    v_exp_f32 v154, v138
    v_cos_f32 v146, v139
    v_sin_f32 v147, v139
    v_exp_f32 v156, v140
    v_cos_f32 v148, v141
    v_sin_f32 v149, v141
    v_mul_f32 v150, v150, v158
    v_mul_f32 v151, v151, v158
    v_mul_f32 v144, v144, v152
    v_mul_f32 v145, v145, v152
    v_mul_f32 v146, v146, v154
    v_mul_f32 v147, v147, v154
    v_mul_f32 v148, v148, v156
    v_mul_f32 v149, v149, v156
    v_mul_f32 v136, v150, v106
    v_mul_f32_e64 v137, -v151, v106
    v_cvt_pk_f16_f32 v111, v144, v145
    v_fma_f32 v136, -v151, v107, v136
    v_fma_f32 v137, -v150, v107, v137
    v_cvt_pk_f16_f32 v115, v146, v147
    v_cvt_pk_f16_f32 v119, v148, v149
    v_cvt_pk_f16_f32 v123, v136, v137
    s_nop 1
    v_mfma_f32_16x16x32_f16 v[124:127], v[108:111], v[120:123], v[124:127]
    v_mfma_f32_16x16x32_f16 v[128:131], v[112:115], v[120:123], v[128:131]
    v_mfma_f32_16x16x32_f16 v[132:135], v[116:119], v[120:123], v[132:135]
    ds_read_b128 v[24:27], v3 offset:16
    s_setprio 1
    v_lshrrev_b32 v28, 1, v1
    v_and_b32 v29, 1, v1
    s_lshl_b32 s81, s35, 19
    s_lshl_b32 s83, s67, 5
    s_add_u32 s81, s81, s83
    s_add_u32 s81, s81, 1048576
    v_lshlrev_b32 v6, 13, v28
    v_lshl_add_u32 v6, v29, 4, v6
    v_add_u32 v6, s81, v6
    s_lshl_b32 s81, s35, 10
    s_sub_u32 s81, 9424, s81
    v_mul_u32_u24 v29, 4608, v29
    v_lshlrev_b32 v28, 4, v28
    v_sub_u32 v29, v29, v28
    v_add_u32 v7, s81, v29
    s_mov_b32 s84, 262144
    s_waitcnt lgkmcnt(0)
L_chk_41:
    v_min3_u32 v24, v24, v25, v26
    v_min_u32 v24, v24, v27
    v_cmp_gt_u32 vcc, 2, v24
    s_cbranch_vccnz L_slow_42
    s_waitcnt vmcnt(0)
    s_lshr_b32 s81, s35, 1
    s_mul_i32 s82, s81, 2576
    s_bitcmp1_b32 s35, 0
    s_cselect_b32 s81, 5152, 0
    s_add_u32 s82, s82, s81
    s_add_u32 s82, s82, 704
    v_add_u32 v12, s82, v12
    v_add_u32 v13, s82, v13
    v_add_u32 v14, s82, v14
    v_add_u32 v15, s82, v15
    v_mul_f32 v124, v124, v42
    v_mul_f32 v125, v125, v42
    v_mul_f32 v126, v126, v42
    v_mul_f32 v127, v127, v42
    v_mul_f32 v128, v128, v42
    v_mul_f32 v129, v129, v42
    v_mul_f32 v130, v130, v42
    v_mul_f32 v131, v131, v42
    v_mul_f32 v132, v132, v42
    v_mul_f32 v133, v133, v42
    v_mul_f32 v134, v134, v42
    v_mul_f32 v135, v135, v42
    ds_write_b128 v14, v[124:127]
    ds_write_b64 v12, v[128:129]
    ds_write_b64 v13, v[130:131]
    s_mov_b32 exec_hi, 1
    ds_write_b32 v15, v132
    s_mov_b32 exec_hi, 0
    ds_write_b32 v15, v133 offset:64
    ds_write_b32 v15, v134 offset:128
    ds_write_b32 v15, v135 offset:192
    s_mov_b32 exec_hi, -1
    v_mov_b32 v29, 3
    ds_write_b32 v20, v29
    ds_read_b128 v[24:27], v3 offset:16
    v_lshrrev_b32 v30, 5, v1
    v_and_b32 v31, 31, v1
    v_mul_u32_u24 v32, 2576, v30
    v_mul_u32_u24 v33, 16640, v30
    s_waitcnt lgkmcnt(0)
L_chk_46:
    v_min3_u32 v24, v24, v25, v26
    v_min_u32 v24, v24, v27
    v_cmp_gt_u32 vcc, 3, v24
    s_cbranch_vccnz L_slow_47
    s_mov_b32 s48, s24
    s_mov_b32 s49, s25
    s_mov_b32 s50, 1409024
    s_mov_b32 s51, 0x20000
    s_mul_i32 s78, s37, 44032
    s_mul_i32 s79, s35, 11136
    s_add_u32 s78, s78, s79
    v_lshlrev_b32 v39, 7, v1
    v_add_u32 v39, s78, v39
    v_cmp_gt_u32 vcc, 29, v1
    v_mov_b32 v36, 1073741824
    s_nop 0
    v_cndmask_b32 v39, v36, v39, vcc
    ds_read_b128 v[24:27], v3 offset:0
    s_waitcnt lgkmcnt(0)
L_chk_48:
    v_min3_u32 v24, v24, v25, v26
    v_min_u32 v24, v24, v27
    v_cmp_gt_u32 vcc, 7, v24
    s_cbranch_vccnz L_slow_49
    global_load_dword v4, v5, s[32:33] sc1
    s_waitcnt vmcnt(0)
L_pchk_50:
    v_cmp_ne_u32 vcc, s73, v4
    s_cbranch_vccnz L_pslow_51
    buffer_load_dwordx4 v[44:47], v6, s[52:55], 0 offen sc1
    buffer_load_dwordx4 v[48:51], v6, s[52:55], s84 offen sc1
    s_mov_b32 s3, 0
    buffer_load_dword v36, v39, s[48:51], s3 offen
    s_mov_b32 s3, 3712
    buffer_load_dword v37, v39, s[48:51], s3 offen
    s_mov_b32 s3, 7424
    buffer_load_dword v38, v39, s[48:51], s3 offen
    s_cmp_eq_u32 s35, 1
    s_cbranch_scc1 L_ex1_43
    s_cmp_gt_u32 s35, 1
    s_cbranch_scc1 L_ex2_44
    v_lshl_add_u32 v28, v31, 5, v32
    v_lshl_add_u32 v29, v31, 4, v33
    ds_read_b128 v[52:55], v28 offset:704
    ds_read_b128 v[56:59], v28 offset:720
    ds_read_b128 v[60:63], v28 offset:736
    ds_read_b32 v64, v16 offset:704
    ds_read_b128 v[68:71], v28 offset:5856
    ds_read_b128 v[72:75], v28 offset:5872
    ds_read_b128 v[76:79], v28 offset:5888
    ds_read_b32 v80, v16 offset:5856
    v_lshl_add_u32 v28, v31, 4, v32
    ds_read_b128 v[116:119], v28 offset:1728
    ds_read_b64 v[120:121], v28 offset:1744
    ds_read_b128 v[124:127], v28 offset:6880
    ds_read_b64 v[128:129], v28 offset:6896
    v_mov_b32 v30, 4
    ds_write_b32 v20, v30
    v_lshrrev_b32 v34, 1, v1
    v_mul_u32_u24 v34, 4160, v34
    v_and_b32 v35, 1, v1
    v_lshl_add_u32 v34, v35, 4, v34
    v_mov_b32 v112, 0
    v_mov_b32 v113, 0
    v_mov_b32 v114, 0
    v_mov_b32 v115, 0
    s_mov_b64 exec, 0xffff
    ds_write_b128 v34, v[112:115] offset:15072
    s_mov_b64 exec, -1
    v_add_u32 v29, 32, v29
    s_waitcnt lgkmcnt(6)
    v_add_f32 v52, v52, v68
    v_add_f32 v53, v53, v69
    v_add_f32 v54, v54, v70
    v_add_f32 v55, v55, v71
    v_add_f32 v56, v56, v72
    v_add_f32 v57, v57, v73
    v_add_f32 v58, v58, v74
    v_add_f32 v59, v59, v75
    v_add_f32 v60, v60, v76
    v_add_f32 v61, v61, v77
    v_add_f32 v62, v62, v78
    v_add_f32 v64, v64, v80
    v_cvt_pk_bf16_f32 v84, v52, v53
    v_cvt_pk_bf16_f32 v85, v54, v55
    v_cvt_pk_bf16_f32 v86, v56, v57
    v_cvt_pk_bf16_f32 v87, v58, v59
    ds_write_b128 v29, v[84:87] offset:15072
    v_cvt_pk_bf16_f32 v88, v53, v54
    v_cvt_pk_bf16_f32 v89, v55, v56
    v_cvt_pk_bf16_f32 v90, v57, v58
    v_cvt_pk_bf16_f32 v91, v59, v60
    ds_write_b128 v29, v[88:91] offset:19232
    v_cvt_pk_bf16_f32 v92, v54, v55
    v_cvt_pk_bf16_f32 v93, v56, v57
    v_cvt_pk_bf16_f32 v94, v58, v59
    v_cvt_pk_bf16_f32 v95, v60, v61
    ds_write_b128 v29, v[92:95] offset:23392
    v_cvt_pk_bf16_f32 v96, v55, v56
    v_cvt_pk_bf16_f32 v97, v57, v58
    v_cvt_pk_bf16_f32 v98, v59, v60
    v_cvt_pk_bf16_f32 v99, v61, v62
    ds_write_b128 v29, v[96:99] offset:27552
    v_add_u32 v29, 512, v29
    v_cvt_pk_bf16_f32 v64, v64, v64
    s_waitcnt lgkmcnt(6)
    v_add_f32 v52, v116, v124
    v_add_f32 v53, v117, v125
    v_add_f32 v54, v118, v126
    v_add_f32 v55, v119, v127
    v_add_f32 v56, v120, v128
    v_add_f32 v57, v121, v129
    v_cvt_pk_bf16_f32 v84, v52, v52
    v_cvt_pk_bf16_f32 v85, v53, v54
    v_cvt_pk_bf16_f32 v86, v54, v54
    v_cvt_pk_bf16_f32 v87, v55, v56
    ds_write_b128 v29, v[84:87] offset:15072
    v_cvt_pk_bf16_f32 v88, v52, v53
    v_cvt_pk_bf16_f32 v89, v54, v54
    v_cvt_pk_bf16_f32 v90, v54, v55
    v_cvt_pk_bf16_f32 v91, v56, v56
    ds_write_b128 v29, v[88:91] offset:19232
    v_cvt_pk_bf16_f32 v92, v53, v54
    v_cvt_pk_bf16_f32 v93, v54, v54
    v_cvt_pk_bf16_f32 v94, v55, v56
    v_cvt_pk_bf16_f32 v95, v56, v56
    ds_write_b128 v29, v[92:95] offset:23392
    v_cvt_pk_bf16_f32 v96, v54, v54
    v_cvt_pk_bf16_f32 v97, v54, v55
    v_cvt_pk_bf16_f32 v98, v56, v56
    v_cvt_pk_bf16_f32 v99, v56, v57
    ds_write_b128 v29, v[96:99] offset:27552
    ds_write_b16 v17, v64
    s_branch L_exend_45
L_ex1_43:
    v_lshl_add_u32 v28, v31, 4, v32
    v_lshl_add_u32 v29, v31, 5, v33
    ds_read_b128 v[52:55], v28 offset:2240
    ds_read_b32 v56, v28 offset:2256
    ds_read_b128 v[68:71], v28 offset:7392
    ds_read_b32 v72, v28 offset:7408
    v_mov_b32 v30, 4
    ds_write_b32 v20, v30
    v_add_u32 v29, 1056, v29
    s_waitcnt lgkmcnt(1)
    v_add_f32 v52, v52, v68
    v_add_f32 v53, v53, v69
    v_add_f32 v54, v54, v70
    v_add_f32 v55, v55, v71
    v_add_f32 v56, v56, v72
    v_cvt_pk_bf16_f32 v84, v52, v52
    v_cvt_pk_bf16_f32 v85, v52, v53
    v_cvt_pk_bf16_f32 v86, v53, v53
    v_cvt_pk_bf16_f32 v87, v54, v54
    v_cvt_pk_bf16_f32 v88, v54, v54
    v_cvt_pk_bf16_f32 v89, v54, v55
    v_cvt_pk_bf16_f32 v90, v55, v55
    v_cvt_pk_bf16_f32 v91, v56, v56
    ds_write_b128 v29, v[84:87] offset:15072
    ds_write_b128 v29, v[88:91] offset:15088
    v_cvt_pk_bf16_f32 v92, v52, v52
    v_cvt_pk_bf16_f32 v93, v53, v53
    v_cvt_pk_bf16_f32 v94, v53, v54
    v_cvt_pk_bf16_f32 v95, v54, v54
    v_cvt_pk_bf16_f32 v96, v54, v54
    v_cvt_pk_bf16_f32 v97, v55, v55
    v_cvt_pk_bf16_f32 v98, v55, v56
    v_cvt_pk_bf16_f32 v99, v56, v56
    ds_write_b128 v29, v[92:95] offset:19232
    ds_write_b128 v29, v[96:99] offset:19248
    v_cvt_pk_bf16_f32 v100, v52, v53
    v_cvt_pk_bf16_f32 v101, v53, v53
    v_cvt_pk_bf16_f32 v102, v54, v54
    v_cvt_pk_bf16_f32 v103, v54, v54
    v_cvt_pk_bf16_f32 v104, v54, v55
    v_cvt_pk_bf16_f32 v105, v55, v55
    v_cvt_pk_bf16_f32 v106, v56, v56
    v_cvt_pk_bf16_f32 v107, v56, v56
    ds_write_b128 v29, v[100:103] offset:23392
    ds_write_b128 v29, v[104:107] offset:23408
    v_cvt_pk_bf16_f32 v108, v53, v53
    v_cvt_pk_bf16_f32 v109, v53, v54
    v_cvt_pk_bf16_f32 v110, v54, v54
    v_cvt_pk_bf16_f32 v111, v54, v54
    v_cvt_pk_bf16_f32 v112, v55, v55
    v_cvt_pk_bf16_f32 v113, v55, v56
    v_cvt_pk_bf16_f32 v114, v56, v56
    v_cvt_pk_bf16_f32 v115, v56, v56
    ds_write_b128 v29, v[108:111] offset:27552
    ds_write_b128 v29, v[112:115] offset:27568
    s_branch L_exend_45
L_ex2_44:
    s_and_b32 s82, s35, 1
    s_mul_i32 s83, s82, 2576
    s_mul_i32 s82, s82, 16640
    s_add_u32 s82, s82, 2080
    v_lshl_add_u32 v28, v1, 3, s83
    v_lshl_add_u32 v29, v1, 5, s82
    ds_read_b64 v[52:53], v28 offset:2752
    ds_read_b32 v54, v28 offset:2760
    ds_read_b64 v[68:69], v28 offset:7904
    ds_read_b32 v70, v28 offset:7912
    v_mov_b32 v30, 4
    ds_write_b32 v20, v30
    s_waitcnt lgkmcnt(1)
    v_add_f32 v52, v52, v68
    v_add_f32 v53, v53, v69
    v_add_f32 v54, v54, v70
    v_cvt_pk_bf16_f32 v84, v52, v52
    v_cvt_pk_bf16_f32 v85, v52, v52
    v_cvt_pk_bf16_f32 v86, v52, v53
    v_cvt_pk_bf16_f32 v87, v53, v53
    v_cvt_pk_bf16_f32 v88, v53, v53
    v_cvt_pk_bf16_f32 v89, v53, v53
    v_cvt_pk_bf16_f32 v90, v54, v54
    v_cvt_pk_bf16_f32 v91, v54, v54
    ds_write_b128 v29, v[84:87] offset:15072
    ds_write_b128 v29, v[88:91] offset:15088
    v_cvt_pk_bf16_f32 v92, v52, v52
    v_cvt_pk_bf16_f32 v93, v52, v52
    v_cvt_pk_bf16_f32 v94, v53, v53
    v_cvt_pk_bf16_f32 v95, v53, v53
    v_cvt_pk_bf16_f32 v96, v53, v53
    v_cvt_pk_bf16_f32 v97, v53, v54
    v_cvt_pk_bf16_f32 v98, v54, v54
    v_cvt_pk_bf16_f32 v99, v54, v54
    ds_write_b128 v29, v[92:95] offset:19232
    ds_write_b128 v29, v[96:99] offset:19248
    v_cvt_pk_bf16_f32 v100, v52, v52
    v_cvt_pk_bf16_f32 v101, v52, v53
    v_cvt_pk_bf16_f32 v102, v53, v53
    v_cvt_pk_bf16_f32 v103, v53, v53
    v_cvt_pk_bf16_f32 v104, v53, v53
    v_cvt_pk_bf16_f32 v105, v54, v54
    v_cvt_pk_bf16_f32 v106, v54, v54
    v_cvt_pk_bf16_f32 v107, v54, v54
    ds_write_b128 v29, v[100:103] offset:23392
    ds_write_b128 v29, v[104:107] offset:23408
    v_cvt_pk_bf16_f32 v108, v52, v52
    v_cvt_pk_bf16_f32 v109, v53, v53
    v_cvt_pk_bf16_f32 v110, v53, v53
    v_cvt_pk_bf16_f32 v111, v53, v53
    v_cvt_pk_bf16_f32 v112, v53, v54
    v_cvt_pk_bf16_f32 v113, v54, v54
    v_cvt_pk_bf16_f32 v114, v54, v54
    v_cvt_pk_bf16_f32 v115, v54, v54
    ds_write_b128 v29, v[108:111] offset:27552
    ds_write_b128 v29, v[112:115] offset:27568
L_exend_45:
    ds_read_b128 v[24:27], v3 offset:16
    v_mov_b32 v84, 0
    v_mov_b32 v85, 0
    v_and_b32 v28, 15, v1
    v_lshlrev_b32 v28, 3, v28
    s_lshr_b32 s82, s35, 1
    s_mul_i32 s82, s82, 4608
    s_and_b32 s83, s35, 1
    s_lshl_b32 s83, s83, 8
    s_add_u32 s83, s83, s82
    v_and_b32 v28, 31, v1
    v_lshl_add_u32 v28, v28, 3, s83
    s_waitcnt lgkmcnt(0)
L_chk_52:
    v_min3_u32 v24, v24, v25, v26
    v_min_u32 v24, v24, v27
    v_cmp_gt_u32 vcc, 4, v24
    s_cbranch_vccnz L_slow_53
    ds_write_b64 v28, v[84:85] offset:9952
    s_waitcnt vmcnt(3)
    ds_write_b128 v7, v[44:47] offset:512
    ds_write_b128 v7, v[48:51]
    v_mov_b32 v29, 5
    ds_write_b32 v20, v29
    ds_read_b128 v[24:27], v3 offset:16
    v_and_b32 v28, 15, v1
    v_lshrrev_b32 v29, 4, v1
    v_add_u32 v30, 1, v28
    v_and_b32 v31, 3, v30
    v_lshrrev_b32 v30, 2, v30
    v_mul_u32_u24 v31, 4160, v31
    v_lshl_add_u32 v31, v30, 3, v31
    v_lshl_add_u32 v31, v29, 4, v31
    s_lshr_b32 s78, s35, 1
    s_and_b32 s79, s35, 1
    s_mul_i32 s80, s78, 16640
    s_lshl_b32 s81, s79, 8
    s_add_u32 s83, s80, s81
    s_add_u32 s83, s83, 15072
    v_add_u32 v4, s83, v31
    s_add_u32 s83, s82, s81
    s_add_u32 s83, s83, 6336
    v_lshlrev_b32 v30, 4, v29
    v_lshlrev_b32 v31, 5, v28
    v_sub_u32 v30, v30, v31
    v_add_u32 v5, s83, v30
    s_waitcnt lgkmcnt(0)
L_chk_54:
    v_min3_u32 v24, v24, v25, v26
    v_min_u32 v24, v24, v27
    v_cmp_gt_u32 vcc, 5, v24
    s_cbranch_vccnz L_slow_55
    ds_read_b128 v[24:27], v3 offset:0
    s_waitcnt lgkmcnt(0)
L_chk_56:
    v_min3_u32 v24, v24, v25, v26
    v_min_u32 v24, v24, v27
    v_cmp_gt_u32 vcc, 11, v24
    s_cbranch_vccnz L_slow_57
    s_setprio 0
    s_add_u32 s3, s2, s35
    s_cmp_eq_u32 s3, 0
    s_cbranch_scc1 L_tagupd_58
L_tagret_59:
    ds_read_b128 v[136:139], v5 offset:3584
    ds_read_b64 v[72:73], v4 offset:0
    ds_read_b64 v[74:75], v4 offset:8
    ds_read_b128 v[140:143], v5 offset:3072
    ds_read_b64 v[76:77], v4 offset:512
    ds_read_b64 v[78:79], v4 offset:520
    ds_read_b128 v[144:147], v5 offset:2560
    ds_read_b64 v[80:81], v4 offset:1024
    ds_read_b64 v[82:83], v4 offset:1032
    ds_read_b128 v[148:151], v5 offset:2048
    ds_read_b64 v[84:85], v4 offset:1536
    ds_read_b64 v[86:87], v4 offset:1544
    ds_read_b128 v[152:155], v5 offset:1536
    ds_read_b64 v[88:89], v4 offset:2048
    ds_read_b64 v[90:91], v4 offset:2056
    ds_read_b128 v[156:159], v5 offset:1024
    ds_read_b64 v[92:93], v4 offset:2560
    ds_read_b64 v[94:95], v4 offset:2568
    ds_read_b128 v[160:163], v5 offset:512
    ds_read_b64 v[96:97], v4 offset:3072
    ds_read_b64 v[98:99], v4 offset:3080
    ds_read_b128 v[164:167], v5 offset:0
    ds_read_b64 v[100:101], v4 offset:3584
    ds_read_b64 v[102:103], v4 offset:3592
    s_waitcnt lgkmcnt(14)
    v_mfma_f32_16x16x32_bf16 v[40:43], v[72:75], v[136:139], 0
    ds_read_b128 v[168:171], v5 offset:3648
    s_waitcnt lgkmcnt(14)
    v_mfma_f32_16x16x32_bf16 v[44:47], v[76:79], v[136:139], 0
    ds_read_b64 v[104:105], v4 offset:64
    ds_read_b64 v[106:107], v4 offset:72
    v_mfma_f32_16x16x32_bf16 v[48:51], v[76:79], v[140:143], 0
    v_mfma_f32_16x16x32_bf16 v[44:47], v[72:75], v[140:143], v[44:47]
    ds_read_b128 v[172:175], v5 offset:3136
    s_waitcnt lgkmcnt(14)
    v_mfma_f32_16x16x32_bf16 v[48:51], v[80:83], v[136:139], v[48:51]
    ds_read_b64 v[108:109], v4 offset:576
    ds_read_b64 v[110:111], v4 offset:584
    v_mfma_f32_16x16x32_bf16 v[52:55], v[80:83], v[140:143], 0
    v_mfma_f32_16x16x32_bf16 v[56:59], v[80:83], v[144:147], 0
    ds_read_b128 v[176:179], v5 offset:2624
    v_mfma_f32_16x16x32_bf16 v[48:51], v[72:75], v[144:147], v[48:51]
    ds_read_b64 v[112:113], v4 offset:1088
    ds_read_b64 v[114:115], v4 offset:1096
    v_mfma_f32_16x16x32_bf16 v[52:55], v[76:79], v[144:147], v[52:55]
    s_waitcnt lgkmcnt(14)
    v_mfma_f32_16x16x32_bf16 v[52:55], v[84:87], v[136:139], v[52:55]
    ds_read_b128 v[180:183], v5 offset:2112
    v_mfma_f32_16x16x32_bf16 v[56:59], v[84:87], v[140:143], v[56:59]
    ds_read_b64 v[116:117], v4 offset:1600
    ds_read_b64 v[118:119], v4 offset:1608
    v_mfma_f32_16x16x32_bf16 v[60:63], v[84:87], v[144:147], 0
    v_mfma_f32_16x16x32_bf16 v[64:67], v[84:87], v[148:151], 0
    ds_read_b128 v[184:187], v5 offset:1600
    v_mfma_f32_16x16x32_bf16 v[52:55], v[72:75], v[148:151], v[52:55]
    ds_read_b64 v[120:121], v4 offset:2112
    ds_read_b64 v[122:123], v4 offset:2120
    v_mfma_f32_16x16x32_bf16 v[56:59], v[76:79], v[148:151], v[56:59]
    v_mfma_f32_16x16x32_bf16 v[60:63], v[80:83], v[148:151], v[60:63]
    ds_read_b128 v[188:191], v5 offset:1088
    s_waitcnt lgkmcnt(14)
    v_mfma_f32_16x16x32_bf16 v[56:59], v[88:91], v[136:139], v[56:59]
    ds_read_b64 v[124:125], v4 offset:2624
    ds_read_b64 v[126:127], v4 offset:2632
    v_mfma_f32_16x16x32_bf16 v[60:63], v[88:91], v[140:143], v[60:63]
    v_mfma_f32_16x16x32_bf16 v[64:67], v[88:91], v[144:147], v[64:67]
    ds_read_b128 v[192:195], v5 offset:576
    v_mfma_f32_16x16x32_bf16 v[68:71], v[88:91], v[148:151], 0
    ds_read_b64 v[128:129], v4 offset:3136
    ds_read_b64 v[130:131], v4 offset:3144
    v_mfma_f32_16x16x32_bf16 v[56:59], v[72:75], v[152:155], v[56:59]
    v_mfma_f32_16x16x32_bf16 v[60:63], v[76:79], v[152:155], v[60:63]
    ds_read_b128 v[196:199], v5 offset:64
    v_mfma_f32_16x16x32_bf16 v[64:67], v[80:83], v[152:155], v[64:67]
    ds_read_b64 v[132:133], v4 offset:3648
    ds_read_b64 v[134:135], v4 offset:3656
    v_mfma_f32_16x16x32_bf16 v[68:71], v[84:87], v[152:155], v[68:71]
    s_waitcnt lgkmcnt(14)
    v_mfma_f32_16x16x32_bf16 v[60:63], v[92:95], v[136:139], v[60:63]
    v_mfma_f32_16x16x32_bf16 v[64:67], v[92:95], v[140:143], v[64:67]
    v_mfma_f32_16x16x32_bf16 v[68:71], v[92:95], v[144:147], v[68:71]
    v_mfma_f32_16x16x32_bf16 v[60:63], v[72:75], v[156:159], v[60:63]
    v_mfma_f32_16x16x32_bf16 v[64:67], v[76:79], v[156:159], v[64:67]
    v_mfma_f32_16x16x32_bf16 v[68:71], v[80:83], v[156:159], v[68:71]
    s_waitcnt lgkmcnt(14)
    v_mfma_f32_16x16x32_bf16 v[64:67], v[96:99], v[136:139], v[64:67]
    v_mfma_f32_16x16x32_bf16 v[68:71], v[96:99], v[140:143], v[68:71]
    v_mfma_f32_16x16x32_bf16 v[64:67], v[72:75], v[160:163], v[64:67]
    v_mfma_f32_16x16x32_bf16 v[68:71], v[76:79], v[160:163], v[68:71]
    s_waitcnt lgkmcnt(14)
    v_mfma_f32_16x16x32_bf16 v[68:71], v[100:103], v[136:139], v[68:71]
    v_mfma_f32_16x16x32_bf16 v[68:71], v[72:75], v[164:167], v[68:71]
    s_waitcnt lgkmcnt(14)
    v_mfma_f32_16x16x32_bf16 v[40:43], v[104:107], v[168:171], v[40:43]
    ds_read_b128 v[136:139], v5 offset:3712
    s_waitcnt lgkmcnt(14)
    v_mfma_f32_16x16x32_bf16 v[44:47], v[108:111], v[168:171], v[44:47]
    ds_read_b64 v[72:73], v4 offset:128
    ds_read_b64 v[74:75], v4 offset:136
    v_mfma_f32_16x16x32_bf16 v[48:51], v[108:111], v[172:175], v[48:51]
    v_mfma_f32_16x16x32_bf16 v[44:47], v[104:107], v[172:175], v[44:47]
    ds_read_b128 v[140:143], v5 offset:3200
    s_waitcnt lgkmcnt(14)
    v_mfma_f32_16x16x32_bf16 v[48:51], v[112:115], v[168:171], v[48:51]
    ds_read_b64 v[76:77], v4 offset:640
    ds_read_b64 v[78:79], v4 offset:648
    v_mfma_f32_16x16x32_bf16 v[52:55], v[112:115], v[172:175], v[52:55]
    v_mfma_f32_16x16x32_bf16 v[56:59], v[112:115], v[176:179], v[56:59]
    ds_read_b128 v[144:147], v5 offset:2688
    v_mfma_f32_16x16x32_bf16 v[48:51], v[104:107], v[176:179], v[48:51]
    ds_read_b64 v[80:81], v4 offset:1152
    ds_read_b64 v[82:83], v4 offset:1160
    v_mfma_f32_16x16x32_bf16 v[52:55], v[108:111], v[176:179], v[52:55]
    s_waitcnt lgkmcnt(14)
    v_mfma_f32_16x16x32_bf16 v[52:55], v[116:119], v[168:171], v[52:55]
    ds_read_b128 v[148:151], v5 offset:2176
    v_mfma_f32_16x16x32_bf16 v[56:59], v[116:119], v[172:175], v[56:59]
    ds_read_b64 v[84:85], v4 offset:1664
    ds_read_b64 v[86:87], v4 offset:1672
    v_mfma_f32_16x16x32_bf16 v[60:63], v[116:119], v[176:179], v[60:63]
    v_mfma_f32_16x16x32_bf16 v[64:67], v[116:119], v[180:183], v[64:67]
    ds_read_b128 v[152:155], v5 offset:1664
    v_mfma_f32_16x16x32_bf16 v[52:55], v[104:107], v[180:183], v[52:55]
    ds_read_b64 v[88:89], v4 offset:2176
    ds_read_b64 v[90:91], v4 offset:2184
    v_mfma_f32_16x16x32_bf16 v[56:59], v[108:111], v[180:183], v[56:59]
    v_mfma_f32_16x16x32_bf16 v[60:63], v[112:115], v[180:183], v[60:63]
    ds_read_b128 v[156:159], v5 offset:1152
    s_waitcnt lgkmcnt(14)
    v_mfma_f32_16x16x32_bf16 v[56:59], v[120:123], v[168:171], v[56:59]
    ds_read_b64 v[92:93], v4 offset:2688
    ds_read_b64 v[94:95], v4 offset:2696
    v_mfma_f32_16x16x32_bf16 v[60:63], v[120:123], v[172:175], v[60:63]
    v_mfma_f32_16x16x32_bf16 v[64:67], v[120:123], v[176:179], v[64:67]
    ds_read_b128 v[160:163], v5 offset:640
    v_mfma_f32_16x16x32_bf16 v[68:71], v[120:123], v[180:183], v[68:71]
    ds_read_b64 v[96:97], v4 offset:3200
    ds_read_b64 v[98:99], v4 offset:3208
    v_mfma_f32_16x16x32_bf16 v[56:59], v[104:107], v[184:187], v[56:59]
    v_mfma_f32_16x16x32_bf16 v[60:63], v[108:111], v[184:187], v[60:63]
    ds_read_b128 v[164:167], v5 offset:128
    v_mfma_f32_16x16x32_bf16 v[64:67], v[112:115], v[184:187], v[64:67]
    ds_read_b64 v[100:101], v4 offset:3712
    ds_read_b64 v[102:103], v4 offset:3720
    v_mfma_f32_16x16x32_bf16 v[68:71], v[116:119], v[184:187], v[68:71]
    s_waitcnt lgkmcnt(14)
    v_mfma_f32_16x16x32_bf16 v[60:63], v[124:127], v[168:171], v[60:63]
    v_mfma_f32_16x16x32_bf16 v[64:67], v[124:127], v[172:175], v[64:67]
    v_mfma_f32_16x16x32_bf16 v[68:71], v[124:127], v[176:179], v[68:71]
    v_mfma_f32_16x16x32_bf16 v[60:63], v[104:107], v[188:191], v[60:63]
    v_mfma_f32_16x16x32_bf16 v[64:67], v[108:111], v[188:191], v[64:67]
    v_mfma_f32_16x16x32_bf16 v[68:71], v[112:115], v[188:191], v[68:71]
    s_waitcnt lgkmcnt(14)
    v_mfma_f32_16x16x32_bf16 v[64:67], v[128:131], v[168:171], v[64:67]
    v_mfma_f32_16x16x32_bf16 v[68:71], v[128:131], v[172:175], v[68:71]
    v_mfma_f32_16x16x32_bf16 v[64:67], v[104:107], v[192:195], v[64:67]
    v_mfma_f32_16x16x32_bf16 v[68:71], v[108:111], v[192:195], v[68:71]
    s_waitcnt lgkmcnt(14)
    v_mfma_f32_16x16x32_bf16 v[68:71], v[132:135], v[168:171], v[68:71]
    v_mfma_f32_16x16x32_bf16 v[68:71], v[104:107], v[196:199], v[68:71]
    s_waitcnt lgkmcnt(14)
    v_mfma_f32_16x16x32_bf16 v[40:43], v[72:75], v[136:139], v[40:43]
    ds_read_b128 v[168:171], v5 offset:3776
    s_waitcnt lgkmcnt(14)
    v_mfma_f32_16x16x32_bf16 v[44:47], v[76:79], v[136:139], v[44:47]
    ds_read_b64 v[104:105], v4 offset:192
    ds_read_b64 v[106:107], v4 offset:200
    v_mfma_f32_16x16x32_bf16 v[48:51], v[76:79], v[140:143], v[48:51]
    v_mfma_f32_16x16x32_bf16 v[44:47], v[72:75], v[140:143], v[44:47]
    ds_read_b128 v[172:175], v5 offset:3264
    s_waitcnt lgkmcnt(14)
    v_mfma_f32_16x16x32_bf16 v[48:51], v[80:83], v[136:139], v[48:51]
    ds_read_b64 v[108:109], v4 offset:704
    ds_read_b64 v[110:111], v4 offset:712
    v_mfma_f32_16x16x32_bf16 v[52:55], v[80:83], v[140:143], v[52:55]
    v_mfma_f32_16x16x32_bf16 v[56:59], v[80:83], v[144:147], v[56:59]
    ds_read_b128 v[176:179], v5 offset:2752
    v_mfma_f32_16x16x32_bf16 v[48:51], v[72:75], v[144:147], v[48:51]
    ds_read_b64 v[112:113], v4 offset:1216
    ds_read_b64 v[114:115], v4 offset:1224
    v_mfma_f32_16x16x32_bf16 v[52:55], v[76:79], v[144:147], v[52:55]
    s_waitcnt lgkmcnt(14)
    v_mfma_f32_16x16x32_bf16 v[52:55], v[84:87], v[136:139], v[52:55]
    ds_read_b128 v[180:183], v5 offset:2240
    v_mfma_f32_16x16x32_bf16 v[56:59], v[84:87], v[140:143], v[56:59]
    ds_read_b64 v[116:117], v4 offset:1728
    ds_read_b64 v[118:119], v4 offset:1736
    v_mfma_f32_16x16x32_bf16 v[60:63], v[84:87], v[144:147], v[60:63]
    v_mfma_f32_16x16x32_bf16 v[64:67], v[84:87], v[148:151], v[64:67]
    ds_read_b128 v[184:187], v5 offset:1728
    v_mfma_f32_16x16x32_bf16 v[52:55], v[72:75], v[148:151], v[52:55]
    ds_read_b64 v[120:121], v4 offset:2240
    ds_read_b64 v[122:123], v4 offset:2248
    v_mfma_f32_16x16x32_bf16 v[56:59], v[76:79], v[148:151], v[56:59]
    v_mfma_f32_16x16x32_bf16 v[60:63], v[80:83], v[148:151], v[60:63]
    ds_read_b128 v[188:191], v5 offset:1216
    s_waitcnt lgkmcnt(14)
    v_mfma_f32_16x16x32_bf16 v[56:59], v[88:91], v[136:139], v[56:59]
    ds_read_b64 v[124:125], v4 offset:2752
    ds_read_b64 v[126:127], v4 offset:2760
    v_mfma_f32_16x16x32_bf16 v[60:63], v[88:91], v[140:143], v[60:63]
    v_mfma_f32_16x16x32_bf16 v[64:67], v[88:91], v[144:147], v[64:67]
    ds_read_b128 v[192:195], v5 offset:704
    v_mfma_f32_16x16x32_bf16 v[68:71], v[88:91], v[148:151], v[68:71]
    ds_read_b64 v[128:129], v4 offset:3264
    ds_read_b64 v[130:131], v4 offset:3272
    v_mfma_f32_16x16x32_bf16 v[56:59], v[72:75], v[152:155], v[56:59]
    v_mfma_f32_16x16x32_bf16 v[60:63], v[76:79], v[152:155], v[60:63]
    ds_read_b128 v[196:199], v5 offset:192
    v_mfma_f32_16x16x32_bf16 v[64:67], v[80:83], v[152:155], v[64:67]
    ds_read_b64 v[132:133], v4 offset:3776
    ds_read_b64 v[134:135], v4 offset:3784
    v_mfma_f32_16x16x32_bf16 v[68:71], v[84:87], v[152:155], v[68:71]
    s_waitcnt lgkmcnt(14)
    v_mfma_f32_16x16x32_bf16 v[60:63], v[92:95], v[136:139], v[60:63]
    v_mfma_f32_16x16x32_bf16 v[64:67], v[92:95], v[140:143], v[64:67]
    v_mfma_f32_16x16x32_bf16 v[68:71], v[92:95], v[144:147], v[68:71]
    v_mfma_f32_16x16x32_bf16 v[60:63], v[72:75], v[156:159], v[60:63]
    v_mfma_f32_16x16x32_bf16 v[64:67], v[76:79], v[156:159], v[64:67]
    v_mfma_f32_16x16x32_bf16 v[68:71], v[80:83], v[156:159], v[68:71]
    s_waitcnt lgkmcnt(14)
    v_mfma_f32_16x16x32_bf16 v[64:67], v[96:99], v[136:139], v[64:67]
    v_mfma_f32_16x16x32_bf16 v[68:71], v[96:99], v[140:143], v[68:71]
    v_mfma_f32_16x16x32_bf16 v[64:67], v[72:75], v[160:163], v[64:67]
    v_mfma_f32_16x16x32_bf16 v[68:71], v[76:79], v[160:163], v[68:71]
    s_waitcnt lgkmcnt(14)
    v_mfma_f32_16x16x32_bf16 v[68:71], v[100:103], v[136:139], v[68:71]
    v_mfma_f32_16x16x32_bf16 v[68:71], v[72:75], v[164:167], v[68:71]
    v_mov_b32 v28, 7
    ds_write_b32 v20, v28
    s_waitcnt lgkmcnt(14)
    v_mfma_f32_16x16x32_bf16 v[40:43], v[104:107], v[168:171], v[40:43]
    s_waitcnt lgkmcnt(14)
    v_mfma_f32_16x16x32_bf16 v[44:47], v[108:111], v[168:171], v[44:47]
    v_mfma_f32_16x16x32_bf16 v[48:51], v[108:111], v[172:175], v[48:51]
    v_mfma_f32_16x16x32_bf16 v[44:47], v[104:107], v[172:175], v[44:47]
    s_waitcnt lgkmcnt(14)
    v_mfma_f32_16x16x32_bf16 v[48:51], v[112:115], v[168:171], v[48:51]
    v_mfma_f32_16x16x32_bf16 v[52:55], v[112:115], v[172:175], v[52:55]
    v_mfma_f32_16x16x32_bf16 v[56:59], v[112:115], v[176:179], v[56:59]
    v_mfma_f32_16x16x32_bf16 v[48:51], v[104:107], v[176:179], v[48:51]
    v_mfma_f32_16x16x32_bf16 v[52:55], v[108:111], v[176:179], v[52:55]
    s_waitcnt lgkmcnt(13)
    v_mfma_f32_16x16x32_bf16 v[52:55], v[116:119], v[168:171], v[52:55]
    v_mfma_f32_16x16x32_bf16 v[56:59], v[116:119], v[172:175], v[56:59]
    v_mfma_f32_16x16x32_bf16 v[60:63], v[116:119], v[176:179], v[60:63]
    v_mfma_f32_16x16x32_bf16 v[64:67], v[116:119], v[180:183], v[64:67]
    v_mfma_f32_16x16x32_bf16 v[52:55], v[104:107], v[180:183], v[52:55]
    v_mfma_f32_16x16x32_bf16 v[56:59], v[108:111], v[180:183], v[56:59]
    v_mfma_f32_16x16x32_bf16 v[60:63], v[112:115], v[180:183], v[60:63]
    s_waitcnt lgkmcnt(10)
    v_mfma_f32_16x16x32_bf16 v[56:59], v[120:123], v[168:171], v[56:59]
    v_mfma_f32_16x16x32_bf16 v[60:63], v[120:123], v[172:175], v[60:63]
    v_mfma_f32_16x16x32_bf16 v[64:67], v[120:123], v[176:179], v[64:67]
    v_mfma_f32_16x16x32_bf16 v[68:71], v[120:123], v[180:183], v[68:71]
    v_mfma_f32_16x16x32_bf16 v[56:59], v[104:107], v[184:187], v[56:59]
    v_mfma_f32_16x16x32_bf16 v[60:63], v[108:111], v[184:187], v[60:63]
    v_mfma_f32_16x16x32_bf16 v[64:67], v[112:115], v[184:187], v[64:67]
    v_mfma_f32_16x16x32_bf16 v[68:71], v[116:119], v[184:187], v[68:71]
    s_waitcnt lgkmcnt(7)
    v_mfma_f32_16x16x32_bf16 v[60:63], v[124:127], v[168:171], v[60:63]
    v_mfma_f32_16x16x32_bf16 v[64:67], v[124:127], v[172:175], v[64:67]
    v_mfma_f32_16x16x32_bf16 v[68:71], v[124:127], v[176:179], v[68:71]
    v_mfma_f32_16x16x32_bf16 v[60:63], v[104:107], v[188:191], v[60:63]
    v_mfma_f32_16x16x32_bf16 v[64:67], v[108:111], v[188:191], v[64:67]
    v_mfma_f32_16x16x32_bf16 v[68:71], v[112:115], v[188:191], v[68:71]
    s_waitcnt lgkmcnt(4)
    v_mfma_f32_16x16x32_bf16 v[64:67], v[128:131], v[168:171], v[64:67]
    v_mfma_f32_16x16x32_bf16 v[68:71], v[128:131], v[172:175], v[68:71]
    v_mfma_f32_16x16x32_bf16 v[64:67], v[104:107], v[192:195], v[64:67]
    v_mfma_f32_16x16x32_bf16 v[68:71], v[108:111], v[192:195], v[68:71]
    s_waitcnt lgkmcnt(1)
    v_mfma_f32_16x16x32_bf16 v[68:71], v[132:135], v[168:171], v[68:71]
    v_mfma_f32_16x16x32_bf16 v[68:71], v[104:107], v[196:199], v[68:71]
    s_setprio 1
    s_add_u32 s80, s80, 15072
    s_lshl_b32 s81, s79, 12
    s_add_u32 s83, s80, s81
    v_lshl_add_u32 v30, v1, 4, s83
    s_xor_b32 s81, s81, 4096
    s_add_u32 s83, s80, s81
    v_lshl_add_u32 v31, v1, 4, s83
    v_and_b32 v28, 15, v1
    v_lshrrev_b32 v29, 4, v1
    v_lshlrev_b32 v28, 5, v28
    v_lshl_add_u32 v28, v29, 3, v28
    s_lshl_b32 s81, s79, 11
    s_sub_u32 s83, s82, s81
    s_add_u32 s83, s83, 8408
    v_sub_u32 v32, s83, v28
    s_add_u32 s83, s80, s81
    s_add_u32 s83, s83, 8192
    v_add_u32 v33, s83, v28
    v_lshl_add_u32 v34, v1, 4, s83
    s_lshl_b32 s83, s67, 13
    s_lshl_b32 s84, s35, 11
    s_add_u32 s83, s83, s84
    s_add_u32 s83, s83, 3145728
    v_lshl_add_u32 v35, v1, 4, s83
    v_mov_b32 v80, s87
    ds_read_b64 v[72:73], v32 offset:1536
    ds_read_b64 v[74:75], v32 offset:1024
    ds_read_b64 v[76:77], v32 offset:512
    ds_read_b64 v[78:79], v32 offset:0
    ds_read_b128 v[24:27], v3 offset:16
    s_waitcnt lgkmcnt(0)
L_chk_60:
    v_min3_u32 v24, v24, v25, v26
    v_min_u32 v24, v24, v27
    v_cmp_gt_u32 vcc, 7, v24
    s_cbranch_vccnz L_slow_61
    s_bitcmp1_b32 s35, 0
    s_cbranch_scc1 L_ck1_62
    ds_write_b128 v30, v[56:59] offset:0
    ds_write_b128 v30, v[60:63] offset:1024
    ds_write_b128 v30, v[64:67] offset:2048
    ds_write_b128 v30, v[68:71] offset:3072
    v_mov_b32 v28, 8
    ds_write_b32 v20, v28
    ds_read_b128 v[24:27], v3 offset:16
    s_waitcnt lgkmcnt(0)
L_chk_64:
    v_min3_u32 v24, v24, v25, v26
    v_min_u32 v24, v24, v27
    v_cmp_gt_u32 vcc, 8, v24
    s_cbranch_vccnz L_slow_65
    ds_read_b128 v[4:7], v31 offset:0
    ds_read_b128 v[8:11], v31 offset:1024
    ds_read_b128 v[12:15], v31 offset:2048
    ds_read_b128 v[16:19], v31 offset:3072
    s_waitcnt lgkmcnt(0)
    v_pk_add_f32 v[4:5], v[4:5], v[40:41]
    v_pk_add_f32 v[6:7], v[6:7], v[42:43]
    v_pk_add_f32 v[8:9], v[8:9], v[44:45]
    v_pk_add_f32 v[10:11], v[10:11], v[46:47]
    v_pk_add_f32 v[12:13], v[12:13], v[48:49]
    v_pk_add_f32 v[14:15], v[14:15], v[50:51]
    v_pk_add_f32 v[16:17], v[16:17], v[52:53]
    v_pk_add_f32 v[18:19], v[18:19], v[54:55]
    s_branch L_ckj_63
L_ck1_62:
    s_nop 7
    ds_write_b128 v30, v[40:43] offset:0
    ds_write_b128 v30, v[44:47] offset:1024
    ds_write_b128 v30, v[48:51] offset:2048
    ds_write_b128 v30, v[52:55] offset:3072
    v_mov_b32 v28, 8
    ds_write_b32 v20, v28
    ds_read_b128 v[24:27], v3 offset:16
    s_waitcnt lgkmcnt(0)
L_chk_66:
    v_min3_u32 v24, v24, v25, v26
    v_min_u32 v24, v24, v27
    v_cmp_gt_u32 vcc, 8, v24
    s_cbranch_vccnz L_slow_67
    ds_read_b128 v[4:7], v31 offset:0
    ds_read_b128 v[8:11], v31 offset:1024
    ds_read_b128 v[12:15], v31 offset:2048
    ds_read_b128 v[16:19], v31 offset:3072
    s_waitcnt lgkmcnt(0)
    v_pk_add_f32 v[4:5], v[4:5], v[56:57]
    v_pk_add_f32 v[6:7], v[6:7], v[58:59]
    v_pk_add_f32 v[8:9], v[8:9], v[60:61]
    v_pk_add_f32 v[10:11], v[10:11], v[62:63]
    v_pk_add_f32 v[12:13], v[12:13], v[64:65]
    v_pk_add_f32 v[14:15], v[14:15], v[66:67]
    v_pk_add_f32 v[16:17], v[16:17], v[68:69]
    v_pk_add_f32 v[18:19], v[18:19], v[70:71]
L_ckj_63:
    v_and_b32 v36, s74, v73
    v_lshlrev_b32 v37, 16, v73
    v_and_b32 v38, s74, v72
    v_lshlrev_b32 v39, 16, v72
    v_pk_fma_f32 v[4:5], v[36:37], v[80:81], v[4:5] op_sel_hi:[1,0,1]
    v_pk_fma_f32 v[6:7], v[38:39], v[80:81], v[6:7] op_sel_hi:[1,0,1]
    v_cvt_pk_bf16_f32 v72, v4, v5
    v_cvt_pk_bf16_f32 v73, v6, v7
    ds_write_b64 v33, v[72:73] offset:0
    v_and_b32 v36, s74, v75
    v_lshlrev_b32 v37, 16, v75
    v_and_b32 v38, s74, v74
    v_lshlrev_b32 v39, 16, v74
    v_pk_fma_f32 v[8:9], v[36:37], v[80:81], v[8:9] op_sel_hi:[1,0,1]
    v_pk_fma_f32 v[10:11], v[38:39], v[80:81], v[10:11] op_sel_hi:[1,0,1]
    v_cvt_pk_bf16_f32 v74, v8, v9
    v_cvt_pk_bf16_f32 v75, v10, v11
    ds_write_b64 v33, v[74:75] offset:512
    v_and_b32 v36, s74, v77
    v_lshlrev_b32 v37, 16, v77
    v_and_b32 v38, s74, v76
    v_lshlrev_b32 v39, 16, v76
    v_pk_fma_f32 v[12:13], v[36:37], v[80:81], v[12:13] op_sel_hi:[1,0,1]
    v_pk_fma_f32 v[14:15], v[38:39], v[80:81], v[14:15] op_sel_hi:[1,0,1]
    v_cvt_pk_bf16_f32 v76, v12, v13
    v_cvt_pk_bf16_f32 v77, v14, v15
    ds_write_b64 v33, v[76:77] offset:1024
    v_and_b32 v36, s74, v79
    v_lshlrev_b32 v37, 16, v79
    v_and_b32 v38, s74, v78
    v_lshlrev_b32 v39, 16, v78
    v_pk_fma_f32 v[16:17], v[36:37], v[80:81], v[16:17] op_sel_hi:[1,0,1]
    v_pk_fma_f32 v[18:19], v[38:39], v[80:81], v[18:19] op_sel_hi:[1,0,1]
    v_cvt_pk_bf16_f32 v78, v16, v17
    v_cvt_pk_bf16_f32 v79, v18, v19
    ds_write_b64 v33, v[78:79] offset:1536
    ds_read_b128 v[4:7], v34
    ds_read_b128 v[8:11], v34 offset:1024
    v_mov_b32 v28, 9
    ds_write_b32 v20, v28
    s_waitcnt lgkmcnt(1)
    buffer_store_dwordx4 v[4:7], v35, s[52:55], 0 offen sc1
    buffer_store_dwordx4 v[8:11], v35, s[52:55], 0 offen offset:1024 sc1
    v_writelane_b32 v22, 40, 0
    s_lshl_b32 s78, s67, 7
    s_add_u32 s78, s78, 69632
    v_and_b32 v28, 7, v1
    v_lshrrev_b32 v29, 3, v1
    s_lshl_b32 s79, s69, 12
    s_lshl_b32 s80, s35, 10
    s_add_u32 s79, s79, s80
    s_add_u32 s79, s79, 69632
    v_lshl_add_u32 v30, v28, 7, s79
    s_lshl_b32 s79, s69, 18
    s_lshl_b32 s80, s35, 16
    s_add_u32 s79, s79, s80
    s_lshl_b32 s80, s68, 7
    s_add_u32 s79, s79, s80
    s_add_u32 s79, s79, 3145728
    v_lshlrev_b32 v31, 12, v29
    v_lshl_add_u32 v31, v28, 4, v31
    v_add_u32 v31, s79, v31
    s_mul_i32 s79, s35, 3072
    v_mul_u32_u24 v32, 192, v29
    v_lshl_add_u32 v32, v28, 4, v32
    v_add_u32 v32, s79, v32
    s_lshl_b32 s79, s68, 16
    s_lshl_b32 s80, s35, 14
    s_add_u32 s79, s79, s80
    s_lshl_b32 s80, s69, 7
    s_add_u32 s79, s79, s80
    v_lshrrev_b32 v34, 4, v1
    v_xor_b32 v28, v28, v34
    v_lshlrev_b32 v29, 10, v29
    v_lshl_add_u32 v33, v28, 4, v29
    v_add_u32 v33, s79, v33
    v_xor_b32 v34, 64, v33
    v_add_u32 v34, 7168, v34
    s_lshl_b32 s80, s35, 11
    s_mov_b32 s83, 32768
    ds_read_b128 v[24:27], v3 offset:16
    s_waitcnt lgkmcnt(0)
L_chk_68:
    v_min3_u32 v24, v24, v25, v26
    v_min_u32 v24, v24, v27
    v_cmp_gt_u32 vcc, 9, v24
    s_cbranch_vccnz L_slow_69
    s_add_u32 m0, s80, 13056
    s_nop 0
    buffer_load_dwordx4 v33, s[40:43], 0 offen lds
    buffer_load_dwordx4 v34, s[40:43], 0 offen offset:1024 lds
    s_waitcnt vmcnt(2)
    ds_add_rtn_u32 v28, v22, v23
    s_waitcnt lgkmcnt(0)
    v_readfirstlane_b32 s3, v28
    s_nop 0
    s_cmp_eq_u32 s3, 3
    s_cbranch_scc1 L_pub_70
L_pubret_71:
    ds_read_b128 v[24:27], v3 offset:0
    s_waitcnt lgkmcnt(0)
L_chk_72:
    v_min3_u32 v24, v24, v25, v26
    v_min_u32 v24, v24, v27
    v_cmp_gt_u32 vcc, 15, v24
    s_cbranch_vccnz L_slow_73
    global_load_dword v36, v30, s[32:33] sc1
    s_waitcnt vmcnt(0)
L_pchk_74:
    v_cmp_ne_u32 vcc, s73, v36
    s_cbranch_vccnz L_pslow_75
    buffer_load_dwordx4 v[4:7], v31, s[52:55], 0 offen sc1
    buffer_load_dwordx4 v[8:11], v31, s[52:55], s83 offen sc1
    s_waitcnt vmcnt(0)
    ds_write_b128 v32, v[4:7] offset:704
    ds_write_b128 v32, v[8:11] offset:2240
    v_mov_b32 v28, 10
    ds_write_b32 v20, v28
    s_waitcnt vmcnt(0) lgkmcnt(0)
    s_endpgm
L_slow_2:
    s_nop 0
    ds_read_b128 v[36:39], v7 offset:0
    s_add_u32 s88, s88, 1
    s_cmp_ge_u32 s88, 0x40000
    s_cbranch_scc1 L_end
    s_waitcnt lgkmcnt(0)
    s_branch L_chk_1
L_slow_4:
    s_nop 0
    ds_read_b128 v[36:39], v7 offset:0
    s_add_u32 s88, s88, 1
    s_cmp_ge_u32 s88, 0x40000
    s_cbranch_scc1 L_end
    s_waitcnt lgkmcnt(0)
    s_branch L_chk_3
L_slow_6:
    s_nop 0
    ds_read_b128 v[36:39], v7 offset:0
    s_add_u32 s88, s88, 1
    s_cmp_ge_u32 s88, 0x40000
    s_cbranch_scc1 L_end
    s_waitcnt lgkmcnt(0)
    s_branch L_chk_5
L_slow_8:
    s_nop 0
    ds_read_b128 v[36:39], v7 offset:0
    s_add_u32 s88, s88, 1
    s_cmp_ge_u32 s88, 0x40000
    s_cbranch_scc1 L_end
    s_waitcnt lgkmcnt(0)
    s_branch L_chk_7
L_slow_10:
    s_nop 0
    ds_read_b128 v[36:39], v7 offset:0
    s_add_u32 s88, s88, 1
    s_cmp_ge_u32 s88, 0x40000
    s_cbranch_scc1 L_end
    s_waitcnt lgkmcnt(0)
    s_branch L_chk_9
L_slow_12:
    s_nop 0
    ds_read_b128 v[36:39], v7 offset:0
    s_add_u32 s88, s88, 1
    s_cmp_ge_u32 s88, 0x40000
    s_cbranch_scc1 L_end
    s_waitcnt lgkmcnt(0)
    s_branch L_chk_11
L_slow_14:
    s_nop 0
    ds_read_b128 v[36:39], v7 offset:0
    s_add_u32 s88, s88, 1
    s_cmp_ge_u32 s88, 0x40000
    s_cbranch_scc1 L_end
    s_waitcnt lgkmcnt(0)
    s_branch L_chk_13
L_slow_16:
    s_nop 0
    ds_read_b128 v[36:39], v7 offset:0
    s_add_u32 s88, s88, 1
    s_cmp_ge_u32 s88, 0x40000
    s_cbranch_scc1 L_end
    s_waitcnt lgkmcnt(0)
    s_branch L_chk_15
L_pslow_18:
    s_sleep 4
    buffer_load_dwordx4 v[52:55], v42, s[52:55], 0 offen sc1
    s_add_u32 s88, s88, 16
    s_cmp_ge_u32 s88, 0x40000
    s_cbranch_scc1 L_end
    s_waitcnt vmcnt(0)
    s_branch L_pchk_17
L_slow_20:
    s_nop 0
    ds_read_b128 v[36:39], v7 offset:0
    s_add_u32 s88, s88, 1
    s_cmp_ge_u32 s88, 0x40000
    s_cbranch_scc1 L_end
    s_waitcnt lgkmcnt(0)
    s_branch L_chk_19
L_pub_21:
    v_mov_b32 v3, s75
    v_mov_b32 v2, s73
    s_mov_b64 exec, 1
    global_store_dword v3, v2, s[32:33] sc1
    s_mov_b64 exec, -1
    s_nop 1
    s_branch L_pubret_22
L_slow_24:
    s_nop 0
    ds_read_b128 v[36:39], v7 offset:0
    s_add_u32 s88, s88, 1
    s_cmp_ge_u32 s88, 0x40000
    s_cbranch_scc1 L_end
    s_waitcnt lgkmcnt(0)
    s_branch L_chk_23
L_slow_26:
    s_nop 0
    ds_read_b128 v[36:39], v7 offset:0
    s_add_u32 s88, s88, 1
    s_cmp_ge_u32 s88, 0x40000
    s_cbranch_scc1 L_end
    s_waitcnt lgkmcnt(0)
    s_branch L_chk_25
L_pslow_28:
    s_sleep 8
    global_load_dword v4, v19, s[32:33] sc1
    s_add_u32 s88, s88, 16
    s_cmp_ge_u32 s88, 0x40000
    s_cbranch_scc1 L_end
    s_waitcnt vmcnt(0)
    s_branch L_pchk_27
L_slow_30:
    s_nop 0
    ds_read_b128 v[36:39], v7 offset:0
    s_add_u32 s88, s88, 1
    s_cmp_ge_u32 s88, 0x40000
    s_cbranch_scc1 L_end
    s_waitcnt lgkmcnt(0)
    s_branch L_chk_29
L_slow_32:
    s_nop 0
    ds_read_b128 v[36:39], v7 offset:0
    s_add_u32 s88, s88, 1
    s_cmp_ge_u32 s88, 0x40000
    s_cbranch_scc1 L_end
    s_waitcnt lgkmcnt(0)
    s_branch L_chk_31
L_slow_34:
    s_nop 0
    ds_read_b128 v[140:143], v7 offset:0
    s_add_u32 s88, s88, 1
    s_cmp_ge_u32 s88, 0x40000
    s_cbranch_scc1 L_end
    s_waitcnt lgkmcnt(0)
    s_branch L_chk_33
L_slow_36:
    s_sleep 1
    ds_read_b128 v[36:39], v7 offset:16
    s_add_u32 s88, s88, 1
    s_cmp_ge_u32 s88, 0x40000
    s_cbranch_scc1 L_end
    s_waitcnt lgkmcnt(0)
    s_branch L_chk_35
L_slow_38:
    s_nop 0
    ds_read_b128 v[24:27], v3 offset:0
    s_add_u32 s88, s88, 1
    s_cmp_ge_u32 s88, 0x40000
    s_cbranch_scc1 L_end
    s_waitcnt lgkmcnt(0)
    s_branch L_chk_37
L_pub_39:
    v_mov_b32 v31, s82
    v_mov_b32 v30, s73
    s_mov_b64 exec, 1
    global_store_dword v31, v30, s[32:33] sc1
    s_mov_b64 exec, -1
    s_nop 1
    s_branch L_pubret_40
L_slow_42:
    s_nop 0
    ds_read_b128 v[24:27], v3 offset:16
    s_add_u32 s88, s88, 1
    s_cmp_ge_u32 s88, 0x40000
    s_cbranch_scc1 L_end
    s_waitcnt lgkmcnt(0)
    s_branch L_chk_41
L_slow_47:
    s_nop 0
    ds_read_b128 v[24:27], v3 offset:16
    s_add_u32 s88, s88, 1
    s_cmp_ge_u32 s88, 0x40000
    s_cbranch_scc1 L_end
    s_waitcnt lgkmcnt(0)
    s_branch L_chk_46
L_slow_49:
    s_sleep 1
    ds_read_b128 v[24:27], v3 offset:0
    s_add_u32 s88, s88, 1
    s_cmp_ge_u32 s88, 0x40000
    s_cbranch_scc1 L_end
    s_waitcnt lgkmcnt(0)
    s_branch L_chk_48
L_pslow_51:
    s_sleep 12
    global_load_dword v4, v5, s[32:33] sc1
    s_add_u32 s88, s88, 16
    s_cmp_ge_u32 s88, 0x40000
    s_cbranch_scc1 L_end
    s_waitcnt vmcnt(0)
    s_branch L_pchk_50
L_slow_53:
    s_nop 0
    ds_read_b128 v[24:27], v3 offset:16
    s_add_u32 s88, s88, 1
    s_cmp_ge_u32 s88, 0x40000
    s_cbranch_scc1 L_end
    s_waitcnt lgkmcnt(0)
    s_branch L_chk_52
L_slow_55:
    s_nop 0
    ds_read_b128 v[24:27], v3 offset:16
    s_add_u32 s88, s88, 1
    s_cmp_ge_u32 s88, 0x40000
    s_cbranch_scc1 L_end
    s_waitcnt lgkmcnt(0)
    s_branch L_chk_54
L_slow_57:
    s_sleep 1
    ds_read_b128 v[24:27], v3 offset:0
    s_add_u32 s88, s88, 1
    s_cmp_ge_u32 s88, 0x40000
    s_cbranch_scc1 L_end
    s_waitcnt lgkmcnt(0)
    s_branch L_chk_56
L_tagupd_58:
    s_mov_b64 exec, 1
    global_store_dword v3, v2, s[32:33] sc1
    s_mov_b64 exec, -1
    s_branch L_tagret_59
L_slow_61:
    s_nop 0
    ds_read_b128 v[24:27], v3 offset:16
    s_add_u32 s88, s88, 1
    s_cmp_ge_u32 s88, 0x40000
    s_cbranch_scc1 L_end
    s_waitcnt lgkmcnt(0)
    s_branch L_chk_60
L_slow_65:
    s_nop 0
    ds_read_b128 v[24:27], v3 offset:16
    s_add_u32 s88, s88, 1
    s_cmp_ge_u32 s88, 0x40000
    s_cbranch_scc1 L_end
    s_waitcnt lgkmcnt(0)
    s_branch L_chk_64
L_slow_67:
    s_nop 0
    ds_read_b128 v[24:27], v3 offset:16
    s_add_u32 s88, s88, 1
    s_cmp_ge_u32 s88, 0x40000
    s_cbranch_scc1 L_end
    s_waitcnt lgkmcnt(0)
    s_branch L_chk_66
L_slow_69:
    s_nop 0
    ds_read_b128 v[24:27], v3 offset:16
    s_add_u32 s88, s88, 1
    s_cmp_ge_u32 s88, 0x40000
    s_cbranch_scc1 L_end
    s_waitcnt lgkmcnt(0)
    s_branch L_chk_68
L_pub_70:
    v_mov_b32 v29, s78
    v_mov_b32 v28, s73
    s_mov_b64 exec, 1
    global_store_dword v29, v28, s[32:33] sc1
    s_mov_b64 exec, -1
    s_nop 1
    s_branch L_pubret_71
L_slow_73:
    s_sleep 1
    ds_read_b128 v[24:27], v3 offset:0
    s_add_u32 s88, s88, 1
    s_cmp_ge_u32 s88, 0x40000
    s_cbranch_scc1 L_end
    s_waitcnt lgkmcnt(0)
    s_branch L_chk_72
L_pslow_75:
    s_sleep 8
    global_load_dword v36, v30, s[32:33] sc1
    s_add_u32 s88, s88, 16
    s_cmp_ge_u32 s88, 0x40000
    s_cbranch_scc1 L_end
    s_waitcnt vmcnt(0)
    s_branch L_pchk_74
.p2align 4
.type L_tab,@object
L_tab:
.long 0x0, 0x43800000, 0x44800000, 0x0
.long 0x3f800000, 0x43810000, 0x44900000, 0x41000000
.long 0x40000000, 0x43820000, 0x44a00000, 0x41800000
.long 0x40400000, 0x43830000, 0x44b00000, 0x41c00000
.long 0x40800000, 0x43c00000, 0x44c00000, 0x42000000
.long 0x40a00000, 0x43c10000, 0x44d00000, 0x42200000
.long 0x40c00000, 0x43c20000, 0x44e00000, 0x42400000
.long 0x40e00000, 0x43c30000, 0x44f00000, 0x42600000
.long 0x43000000, 0x44000000, 0x45000000, 0x42800000
.long 0x43010000, 0x44010000, 0x45000000, 0x42900000
.long 0x43020000, 0x44200000, 0x45000000, 0x42a00000
.long 0x43030000, 0x44210000, 0x45000000, 0x42b00000
.long 0x43040000, 0x44400000, 0x45000000, 0x42c00000
.long 0x43050000, 0x44410000, 0x45000000, 0x42d00000
.long 0x43060000, 0x44600000, 0x45000000, 0x42e00000
.long 0x43070000, 0x44610000, 0x45000000, 0x42f00000
.long 0x0, 0x43800000, 0x44800000, 0x0
.long 0x3f800000, 0x43810000, 0x44900000, 0x41000000
.long 0x40000000, 0x43820000, 0x44a00000, 0x41800000
.long 0x40400000, 0x43830000, 0x44b00000, 0x41c00000
.long 0x40800000, 0x43c00000, 0x44c00000, 0x42000000
.long 0x40a00000, 0x43c10000, 0x44d00000, 0x42200000
.long 0x40c00000, 0x43c20000, 0x44e00000, 0x42400000
.long 0x40e00000, 0x43c30000, 0x44f00000, 0x42600000
.long 0x43000000, 0x44000000, 0x45000000, 0x42800000
.long 0x43010000, 0x44010000, 0x45000000, 0x42900000
.long 0x43020000, 0x44200000, 0x45000000, 0x42a00000
.long 0x43030000, 0x44210000, 0x45000000, 0x42b00000
.long 0x43040000, 0x44400000, 0x45000000, 0x42c00000
.long 0x43050000, 0x44410000, 0x45000000, 0x42d00000
.long 0x43060000, 0x44600000, 0x45000000, 0x42e00000
.long 0x43070000, 0x44610000, 0x45000000, 0x42f00000
.long 0x0, 0x43800000, 0x44800000, 0x0
.long 0x3f800000, 0x43810000, 0x44900000, 0x41000000
.long 0x40000000, 0x43820000, 0x44a00000, 0x41800000
.long 0x40400000, 0x43830000, 0x44b00000, 0x41c00000
.long 0x40800000, 0x43c00000, 0x44c00000, 0x42000000
.long 0x40a00000, 0x43c10000, 0x44d00000, 0x42200000
.long 0x40c00000, 0x43c20000, 0x44e00000, 0x42400000
.long 0x40e00000, 0x43c30000, 0x44f00000, 0x42600000
.long 0x43000000, 0x44000000, 0x45000000, 0x42800000
.long 0x43010000, 0x44010000, 0x45000000, 0x42900000
.long 0x43020000, 0x44200000, 0x45000000, 0x42a00000
.long 0x43030000, 0x44210000, 0x45000000, 0x42b00000
.long 0x43040000, 0x44400000, 0x45000000, 0x42c00000
.long 0x43050000, 0x44410000, 0x45000000, 0x42d00000
.long 0x43060000, 0x44600000, 0x45000000, 0x42e00000
.long 0x43070000, 0x44610000, 0x45000000, 0x42f00000
.long 0x0, 0x43800000, 0x44800000, 0x0
.long 0x3f800000, 0x43810000, 0x44900000, 0x41000000
.long 0x40000000, 0x43820000, 0x44a00000, 0x41800000
.long 0x40400000, 0x43830000, 0x44b00000, 0x41c00000
.long 0x40800000, 0x43c00000, 0x44c00000, 0x42000000
.long 0x40a00000, 0x43c10000, 0x44d00000, 0x42200000
.long 0x40c00000, 0x43c20000, 0x44e00000, 0x42400000
.long 0x40e00000, 0x43c30000, 0x44f00000, 0x42600000
.long 0x43000000, 0x44000000, 0x45000000, 0x42800000
.long 0x43010000, 0x44010000, 0x45000000, 0x42900000
.long 0x43020000, 0x44200000, 0x45000000, 0x42a00000
.long 0x43030000, 0x44210000, 0x45000000, 0x42b00000
.long 0x43040000, 0x44400000, 0x45000000, 0x42c00000
.long 0x43050000, 0x44410000, 0x45000000, 0x42d00000
.long 0x43060000, 0x44600000, 0x45000000, 0x42e00000
.long 0x43070000, 0x44610000, 0x45000000, 0x42f00000
.long 0x400, 0x408, 0x0, 0x800
.long 0x410, 0x418, 0x20, 0x804
.long 0x420, 0x428, 0x40, 0x808
.long 0x430, 0x438, 0x60, 0x80c
.long 0x440, 0x448, 0x80, 0x810
.long 0x450, 0x458, 0xa0, 0x814
.long 0x460, 0x468, 0xc0, 0x818
.long 0x470, 0x478, 0xe0, 0x81c
.long 0x480, 0x488, 0x100, 0x820
.long 0x490, 0x498, 0x120, 0x824
.long 0x4a0, 0x4a8, 0x140, 0x828
.long 0x4b0, 0x4b8, 0x160, 0x82c
.long 0x4c0, 0x4c8, 0x180, 0x830
.long 0x4d0, 0x4d8, 0x1a0, 0x834
.long 0x4e0, 0x4e8, 0x1c0, 0x838
.long 0x4f0, 0x4f8, 0x1e0, 0x83c
.long 0x500, 0x508, 0x10, 0x900
.long 0x510, 0x518, 0x30, 0x904
.long 0x520, 0x528, 0x50, 0x908
.long 0x530, 0x538, 0x70, 0x90c
.long 0x540, 0x548, 0x90, 0x910
.long 0x550, 0x558, 0xb0, 0x914
.long 0x560, 0x568, 0xd0, 0x918
.long 0x570, 0x578, 0xf0, 0x91c
.long 0x580, 0x588, 0x110, 0x920
.long 0x590, 0x598, 0x130, 0x924
.long 0x5a0, 0x5a8, 0x150, 0x928
.long 0x5b0, 0x5b8, 0x170, 0x92c
.long 0x5c0, 0x5c8, 0x190, 0x930
.long 0x5d0, 0x5d8, 0x1b0, 0x934
.long 0x5e0, 0x5e8, 0x1d0, 0x938
.long 0x5f0, 0x5f8, 0x1f0, 0x93c
.long 0x600, 0x680, 0x200, 0xa00
.long 0x608, 0x688, 0x220, 0xa00
.long 0x610, 0x690, 0x240, 0xa00
.long 0x618, 0x698, 0x260, 0xa00
.long 0x620, 0x6a0, 0x280, 0xa00
.long 0x628, 0x6a8, 0x2a0, 0xa00
.long 0x630, 0x6b0, 0x2c0, 0xa00
.long 0x638, 0x6b8, 0x2e0, 0xa00
.long 0x640, 0x6c0, 0x300, 0xa00
.long 0x648, 0x6c8, 0x320, 0xa00
.long 0x650, 0x6d0, 0x340, 0xa00
.long 0x658, 0x6d8, 0x360, 0xa00
.long 0x660, 0x6e0, 0x380, 0xa00
.long 0x668, 0x6e8, 0x3a0, 0xa00
.long 0x670, 0x6f0, 0x3c0, 0xa00
.long 0x678, 0x6f8, 0x3e0, 0xa00
.long 0x700, 0x780, 0x210, 0xa00
.long 0x708, 0x788, 0x230, 0xa00
.long 0x710, 0x790, 0x250, 0xa00
.long 0x718, 0x798, 0x270, 0xa00
.long 0x720, 0x7a0, 0x290, 0xa00
.long 0x728, 0x7a8, 0x2b0, 0xa00
.long 0x730, 0x7b0, 0x2d0, 0xa00
.long 0x738, 0x7b8, 0x2f0, 0xa00
.long 0x740, 0x7c0, 0x310, 0xa00
.long 0x748, 0x7c8, 0x330, 0xa00
.long 0x750, 0x7d0, 0x350, 0xa00
.long 0x758, 0x7d8, 0x370, 0xa00
.long 0x760, 0x7e0, 0x390, 0xa00
.long 0x768, 0x7e8, 0x3b0, 0xa00
.long 0x770, 0x7f0, 0x3d0, 0xa00
.long 0x778, 0x7f8, 0x3f0, 0xa00
.long 0x0, 0x4b3e, 0x0, 0x0
.long 0x0, 0x5b7c, 0x0, 0x0
.long 0x4, 0x5b7e, 0x0, 0x0
.long 0x0, 0x6bba, 0x0, 0x0
.long 0x4, 0x6bbc, 0x0, 0x0
.long 0x8, 0x6bbe, 0x0, 0x0
.long 0x400, 0x5d7e, 0x0, 0x0
.long 0x400, 0x6dbc, 0x0, 0x0
.long 0x404, 0x6dbe, 0x0, 0x0
.long 0x600, 0x6fbe, 0x0, 0x0
.long 0xa10, 0x8c3e, 0x0, 0x0
.long 0xa10, 0x9c7c, 0x0, 0x0
.long 0xa14, 0x9c7e, 0x0, 0x0
.long 0xa10, 0xacba, 0x0, 0x0
.long 0xa14, 0xacbc, 0x0, 0x0
.long 0xa18, 0xacbe, 0x0, 0x0
.long 0xe10, 0x9e7e, 0x0, 0x0
.long 0xe10, 0xaebc, 0x0, 0x0
.long 0xe14, 0xaebe, 0x0, 0x0
.long 0x1010, 0xb0be, 0x0, 0x0
.long 0x0, 0x210, 0x0, 0x0
.long 0x0, 0x214, 0x0, 0x0
.long 0x0, 0x218, 0x0, 0x0
.long 0x0, 0x21c, 0x0, 0x0
.long 0x0, 0x220, 0x0, 0x0
.long 0x0, 0x224, 0x0, 0x0
.long 0x0, 0x228, 0x0, 0x0
.long 0x0, 0x22c, 0x0, 0x0
.long 0x0, 0x230, 0x0, 0x0
.long 0x0, 0x234, 0x0, 0x0
.long 0x0, 0x238, 0x0, 0x0
.long 0x0, 0x23c, 0x0, 0x0
.long 0x0, 0x240, 0x0, 0x0
.long 0x0, 0x244, 0x0, 0x0
.long 0x0, 0x248, 0x0, 0x0
.long 0x0, 0x24c, 0x0, 0x0
.long 0x0, 0x250, 0x0, 0x0
.long 0x0, 0x254, 0x0, 0x0
.long 0x0, 0x258, 0x0, 0x0
.long 0x0, 0x25c, 0x0, 0x0
.long 0x0, 0x260, 0x0, 0x0
.long 0x0, 0x264, 0x0, 0x0
.long 0x0, 0x268, 0x0, 0x0
.long 0x0, 0x26c, 0x0, 0x0
.long 0x0, 0x270, 0x0, 0x0
.long 0x0, 0x274, 0x0, 0x0
.long 0x0, 0x278, 0x0, 0x0
.long 0x0, 0x27c, 0x0, 0x0
.long 0x0, 0x280, 0x0, 0x0
.long 0x0, 0x284, 0x0, 0x0
.long 0x0, 0x288, 0x0, 0x0
.long 0x0, 0x28c, 0x0, 0x0
.long 0x0, 0x290, 0x0, 0x0
.long 0x0, 0x294, 0x0, 0x0
.long 0x0, 0x298, 0x0, 0x0
.long 0x0, 0x29c, 0x0, 0x0
.long 0x0, 0x2a0, 0x0, 0x0
.long 0x0, 0x2a4, 0x0, 0x0
.long 0x0, 0x2a8, 0x0, 0x0
.long 0x0, 0x2ac, 0x0, 0x0
.long 0x0, 0x2b0, 0x0, 0x0
.long 0x0, 0x2b4, 0x0, 0x0
.long 0x0, 0x2b8, 0x0, 0x0
.long 0x0, 0x2bc, 0x0, 0x0
L_tabend:
.section .rodata,"a"
.p2align 6
.amdhsa_kernel recurrent_scan__ssm_conv_s4d__mixer_channel_mlp__prompt_kernel
  .amdhsa_next_free_vgpr 256
  .amdhsa_next_free_sgpr 102
  .amdhsa_accum_offset 256
  .amdhsa_group_segment_fixed_size 0
  .amdhsa_kernarg_size 120
  .amdhsa_user_sgpr_count 2
  .amdhsa_user_sgpr_kernarg_segment_ptr 1
  .amdhsa_system_sgpr_workgroup_id_x 1
  .amdhsa_float_denorm_mode_32 3
.end_amdhsa_kernel
```
